```python
import torch

def _softmax(x, axis=-1):
    return torch.softmax(x, dim=axis)
def _gelu(x):
    return torch.nn.functional.gelu(x, approximate="tanh")
def _silu(x):
    return torch.nn.functional.silu(x)
def _sigmoid(x):
    return torch.sigmoid(x)
def _layernorm(x, axis=-1, eps=1e-5):
    m = x.mean(dim=axis, keepdim=True)
    v = x.var(dim=axis, keepdim=True, unbiased=False)
    return (x - m) / torch.sqrt(v + eps)
def _scatter_add(tgt, idx, src, axis=0):
    return tgt.clone().index_add_(axis, idx, src)
def _segment_sum(src, seg, n):
    out = torch.zeros((n,) + src.shape[1:], dtype=src.dtype)
    return out.index_add_(0, seg, src)
def _pad(x, pw):
    flat = tuple(v for pair in reversed(pw) for v in pair)
    return torch.nn.functional.pad(x, flat)

kernel_name = 'interleave_layers__grouped_kv_mqa__dense_activation_gelu__prompt'

def setup_inputs():

    _w = (lambda a: (lambda t: t.to(torch.bfloat16) if t.is_floating_point() else t)(torch.as_tensor(a)))
    def _A_setup():
        B, S, D, H = 1, 2048, 640, 32
        Dh = D // H
        return {
            "x": _w((lambda *s: torch.randn(*s, dtype=torch.bfloat16) * 0.05)(B, S, D)),
            "wq": _w((lambda *s: torch.randn(*s, dtype=torch.bfloat16) * 0.05)(D, H * Dh)),
            "wk": _w((lambda *s: torch.randn(*s, dtype=torch.bfloat16) * 0.05)(D, Dh)),
            "wv": _w((lambda *s: torch.randn(*s, dtype=torch.bfloat16) * 0.05)(D, Dh)),
            "wo": _w((lambda *s: torch.randn(*s, dtype=torch.bfloat16) * 0.05)(H * Dh, D)),
        }
    _A_in = _A_setup()

    def _B_setup():
        B, S, D, F = 1, 2048, 640, 1536
        return {
            "x": _w((lambda *s: torch.randn(*s, dtype=torch.bfloat16) * 0.05)(B, S, D)),
            "w1": _w((lambda *s: torch.randn(*s, dtype=torch.bfloat16) * 0.8)(D, F) * (D ** -0.5)),
            "b1": _w((lambda *s: torch.randn(*s, dtype=torch.bfloat16) * 0.8)(F) * 0.01),
            "w2": _w((lambda *s: torch.randn(*s, dtype=torch.bfloat16) * 0.8)(F, D) * (F ** -0.5)),
            "b2": _w((lambda *s: torch.randn(*s, dtype=torch.bfloat16) * 0.8)(D) * 0.01),
        }
    _B_in = _B_setup()

    return {
        "A_x": _A_in["x"],
        "A_wq": _A_in["wq"],
        "A_wk": _A_in["wk"],
        "A_wv": _A_in["wv"],
        "A_wo": _A_in["wo"],
        "B_x": _B_in["x"],
        "B_w1": _B_in["w1"],
        "B_b1": _B_in["b1"],
        "B_w2": _B_in["w2"],
        "B_b2": _B_in["b2"],
    }

def reference(A_x, A_wq, A_wk, A_wv, A_wo, B_x, B_w1, B_b1, B_w2, B_b2):
    def _A_ref(x, wq, wk, wv, wo):
        B, S, D = x.shape
        H = 32
        Dh = D // H
        q = (lambda x, *d: x.permute(*d))((x @ wq).reshape(B, S, H, Dh), 0, 2, 1, 3)
        k = x @ wk
        v = x @ wv
        scores = torch.einsum("bhqd,bkd->bhqk", q, k) * (Dh ** -0.5)
        p = _softmax(scores, axis=-1)
        o = torch.einsum("bhqk,bkd->bhqd", p, v)
        return (lambda x, *d: x.permute(*d))(o, 0, 2, 1, 3).reshape(B, S, H * Dh) @ wo

    def _B_ref(x, w1, b1, w2, b2):
        h = torch.einsum("bsd,df->bsf", x, w1) + b1
        h = _gelu(h)
        return torch.einsum("bsf,fd->bsd", h, w2) + b2

    x = A_x
    x = x + _A_ref(_layernorm(x, axis=-1), A_wq, A_wk, A_wv, A_wo)
    x = x + _B_ref(_layernorm(x, axis=-1), B_w1, B_b1, B_w2, B_b2)
    x = x + _A_ref(_layernorm(x, axis=-1), A_wq, A_wk, A_wv, A_wo)
    x = x + _B_ref(_layernorm(x, axis=-1), B_w1, B_b1, B_w2, B_b2)
    return x
```

```asm
; @launch kernel=l0_kernel grid=(256,1,1) block=(256,1,1) lds=8192
; @launch kernel=main_kernel grid=(256,1,1) block=(256,1,1) lds=163840
.amdgcn_target "amdgcn-amd-amdhsa--gfx950"
.text
.globl l0_kernel
.p2align 8
.type l0_kernel,@function
l0_kernel:
  s_cmp_ge_u32 s2, 256
  s_cbranch_scc1 L0_end
  s_load_dwordx2 s[36:37], s[0:1], 0
  s_load_dwordx2 s[38:39], s[0:1], 8
  s_load_dwordx2 s[40:41], s[0:1], 16
  s_load_dwordx2 s[42:43], s[0:1], 24
  s_load_dwordx2 s[44:45], s[0:1], 32
  s_load_dwordx2 s[46:47], s[0:1], 48
  s_load_dwordx2 s[48:49], s[0:1], 64
  s_load_dwordx2 s[50:51], s[0:1], 96
  s_getpc_b64 s[70:71]
L0_PC:
  s_add_u32 s70, s70, (main_kernel - L0_PC) & 0xffffffff
  s_addc_u32 s71, s71, 0
  s_lshr_b32 s72, s2, 3
  s_mul_i32 s72, s72, 1280
  v_lshlrev_b32 v58, 2, v0
  v_add_u32 v58, s72, v58
  v_min_u32 v57, MAIN_END - main_kernel - 4, v58
  global_load_dword v59, v57, s[70:71]
  v_add_u32 v58, 1024, v58
  v_min_u32 v57, MAIN_END - main_kernel - 4, v58
  global_load_dword v59, v57, s[70:71]
  v_and_b32 v2, 31, v0
  v_lshrrev_b32 v3, 5, v0
  s_waitcnt lgkmcnt(0)
  s_mov_b32 s8, s50
  s_and_b32 s9, s51, 0xffff
  s_mov_b32 s10, 0x10000000
  s_mov_b32 s11, 0x20000
  s_mov_b32 s56, s36
  s_and_b32 s57, s37, 0xffff
  s_mov_b32 s58, 0x280000
  s_mov_b32 s59, 0x20000
  v_lshrrev_b32 v8, 6, v0
  v_and_b32 v4, 7, v0
  v_readfirstlane_b32 s53, v8
  v_bfe_u32 v5, v0, 3, 3
  s_mul_i32 s35, s2, 10240
  v_mul_u32_u24 v6, 1280, v4
  v_lshl_add_u32 v6, v5, 4, v6
  s_lshl_b32 s20, s53, 7
  s_add_u32 s20, s20, s35
  s_cmp_lt_u32 s53, 2
  s_cselect_b32 s54, 0, 0x40000000
  buffer_load_dwordx4 v[64:67], v6, s[56:59], s20 offen offset:0
  buffer_load_dwordx4 v[68:71], v6, s[56:59], s20 offen offset:512
  v_add_u32 v9, s54, v6
  buffer_load_dwordx4 v[72:75], v9, s[56:59], s20 offen offset:1024
  s_cmp_lt_u32 s2, 40
  s_cbranch_scc1 L0_wq
  s_cmp_lt_u32 s2, 80
  s_cbranch_scc1 L0_wo
  s_cmp_lt_u32 s2, 176
  s_cbranch_scc1 L0_w1
  s_branch L0_w2
L0_wq:
  s_sub_u32 s35, s2, 0
  s_lshr_b32 s19, s35, 2
  s_lshl_b32 s19, s19, 6
  s_and_b32 s34, s35, 3
  s_mul_i32 s17, s34, 20
  s_mov_b32 s18, 20
  s_mov_b32 s16, 1280
  s_mov_b32 s12, s38
  s_and_b32 s13, s39, 0xffff
  s_mov_b32 s14, 0xc8000
  s_mov_b32 s15, 0x20000
  s_mov_b32 s21, 1
  s_mov_b32 s22, 1024
  s_mov_b32 s23, 512
  s_mov_b32 s52, 1
  s_mov_b32 s24, s17
  s_mov_b32 s25, 0x90000
  s_mov_b32 s27, 20
  s_mov_b32 s26, 3277
  s_mov_b32 s28, 40960
  s_mov_b32 s29, 256
  s_mov_b32 s30, 1
  s_mov_b32 s31, 1
  s_mul_i32 s32, s34, 4096
  s_add_u32 s32, s32, 0x658000
  s_mov_b32 s33, 128
  s_branch L0_common
L0_wo:
  s_sub_u32 s35, s2, 40
  s_lshr_b32 s19, s35, 2
  s_lshl_b32 s19, s19, 6
  s_and_b32 s34, s35, 3
  s_mul_i32 s17, s34, 20
  s_mov_b32 s18, 20
  s_mov_b32 s16, 1280
  s_mov_b32 s12, s44
  s_and_b32 s13, s45, 0xffff
  s_mov_b32 s14, 0xc8000
  s_mov_b32 s15, 0x20000
  s_mov_b32 s21, 0
  s_mov_b32 s22, 1280
  s_mov_b32 s23, 0
  s_mov_b32 s52, 0
  s_mov_b32 s24, s17
  s_mov_b32 s25, 0x1d0000
  s_mov_b32 s27, 80
  s_mov_b32 s26, 820
  s_mov_b32 s28, 102400
  s_mov_b32 s29, 256
  s_mov_b32 s30, 0
  s_mov_b32 s31, 0
  s_mul_i32 s32, s34, 0
  s_add_u32 s32, s32, 0x0
  s_mov_b32 s33, 0
  s_branch L0_common
L0_w1:
  s_sub_u32 s35, s2, 80
  s_lshr_b32 s19, s35, 2
  s_lshl_b32 s19, s19, 6
  s_and_b32 s34, s35, 3
  s_mul_i32 s17, s34, 20
  s_mov_b32 s18, 20
  s_mov_b32 s16, 3072
  s_mov_b32 s12, s46
  s_and_b32 s13, s47, 0xffff
  s_mov_b32 s14, 0x1e0000
  s_mov_b32 s15, 0x20000
  s_mov_b32 s21, 2
  s_mov_b32 s22, 3072
  s_mov_b32 s23, 256
  s_mov_b32 s52, 3
  s_mov_b32 s24, s17
  s_mov_b32 s25, 0x298000
  s_mov_b32 s27, 48
  s_mov_b32 s26, 1366
  s_mov_b32 s28, 61440
  s_mov_b32 s29, 1024
  s_mov_b32 s30, 0
  s_mov_b32 s31, 1
  s_mul_i32 s32, s34, 6144
  s_add_u32 s32, s32, 0x65c000
  s_mov_b32 s33, 192
  s_branch L0_common
L0_w2:
  s_sub_u32 s35, s2, 176
  s_lshr_b32 s19, s35, 3
  s_lshl_b32 s19, s19, 6
  s_and_b32 s34, s35, 7
  s_mul_i32 s17, s34, 24
  s_mov_b32 s18, 24
  s_mov_b32 s16, 1280
  s_mov_b32 s12, s48
  s_and_b32 s13, s49, 0xffff
  s_mov_b32 s14, 0x1e0000
  s_mov_b32 s15, 0x20000
  s_mov_b32 s21, 2
  s_mov_b32 s22, 5120
  s_mov_b32 s23, 256
  s_mov_b32 s52, 3
  s_and_b32 s24, s34, 1
  s_mul_i32 s24, s24, 24
  s_lshr_b32 s25, s34, 1
  s_mul_i32 s25, s25, 61440
  s_add_u32 s25, s25, 0x478000
  s_mov_b32 s27, 80
  s_mov_b32 s26, 820
  s_mov_b32 s28, 245760
  s_mov_b32 s29, 1024
  s_mov_b32 s30, 0
  s_mov_b32 s31, 0
  s_mul_i32 s32, s34, 0
  s_add_u32 s32, s32, 0x0
  s_mov_b32 s33, 0
  s_branch L0_common
L0_common:
  v_add_u32 v10, s17, v3
  s_lshl_b32 s35, s16, 3
  v_mul_lo_u32 v10, v10, s35
  s_lshl_b32 s35, s19, 1
  v_lshl_add_u32 v10, v2, 2, v10
  v_add_u32 v10, s35, v10
  s_mov_b32 s20, 0
  buffer_load_dword v80, v10, s[12:15], s20 offen
  s_add_u32 s20, s20, s16
  buffer_load_dword v81, v10, s[12:15], s20 offen
  s_add_u32 s20, s20, s16
  buffer_load_dword v82, v10, s[12:15], s20 offen
  s_add_u32 s20, s20, s16
  buffer_load_dword v83, v10, s[12:15], s20 offen
  s_add_u32 s20, s20, s16
  buffer_load_dword v84, v10, s[12:15], s20 offen
  s_add_u32 s20, s20, s16
  buffer_load_dword v85, v10, s[12:15], s20 offen
  s_add_u32 s20, s20, s16
  buffer_load_dword v86, v10, s[12:15], s20 offen
  s_add_u32 s20, s20, s16
  buffer_load_dword v87, v10, s[12:15], s20 offen
  s_mul_i32 s35, s16, 57
  s_add_u32 s20, s20, s35
  buffer_load_dword v88, v10, s[12:15], s20 offen
  s_add_u32 s20, s20, s16
  buffer_load_dword v89, v10, s[12:15], s20 offen
  s_add_u32 s20, s20, s16
  buffer_load_dword v90, v10, s[12:15], s20 offen
  s_add_u32 s20, s20, s16
  buffer_load_dword v91, v10, s[12:15], s20 offen
  s_add_u32 s20, s20, s16
  buffer_load_dword v92, v10, s[12:15], s20 offen
  s_add_u32 s20, s20, s16
  buffer_load_dword v93, v10, s[12:15], s20 offen
  s_add_u32 s20, s20, s16
  buffer_load_dword v94, v10, s[12:15], s20 offen
  s_add_u32 s20, s20, s16
  buffer_load_dword v95, v10, s[12:15], s20 offen
  s_mul_i32 s35, s16, 57
  s_add_u32 s20, s20, s35
  buffer_load_dword v96, v10, s[12:15], s20 offen
  s_add_u32 s20, s20, s16
  buffer_load_dword v97, v10, s[12:15], s20 offen
  s_add_u32 s20, s20, s16
  buffer_load_dword v98, v10, s[12:15], s20 offen
  s_add_u32 s20, s20, s16
  buffer_load_dword v99, v10, s[12:15], s20 offen
  s_add_u32 s20, s20, s16
  buffer_load_dword v100, v10, s[12:15], s20 offen
  s_add_u32 s20, s20, s16
  buffer_load_dword v101, v10, s[12:15], s20 offen
  s_add_u32 s20, s20, s16
  buffer_load_dword v102, v10, s[12:15], s20 offen
  s_add_u32 s20, s20, s16
  buffer_load_dword v103, v10, s[12:15], s20 offen
  s_cmp_lt_u32 s2, 40
  s_cbranch_scc1 L0_nokvld
  s_cmp_ge_u32 s2, 72
  s_cbranch_scc1 L0_nokvld
  s_sub_u32 s66, s2, 40
  s_lshr_b32 s68, s66, 2
  s_and_b32 s66, s66, 3
  s_mul_i32 s67, s66, 20
  v_cmp_gt_u32 vcc, 10, v2
  v_mov_b32 v25, s42
  v_mov_b32 v26, s40
  v_cndmask_b32 v60, v25, v26, vcc
  v_mov_b32 v25, s43
  v_mov_b32 v26, s41
  v_cndmask_b32 v61, v25, v26, vcc
  v_subrev_u32 v25, 10, v2
  v_cndmask_b32 v25, v25, v2, vcc
  v_cmp_gt_u32 vcc, 20, v2
  s_nop 1
  v_cndmask_b32 v25, 0, v25, vcc
  v_add_u32 v26, s67, v3
  v_mul_u32_u24 v26, 320, v26
  v_lshl_add_u32 v26, v25, 2, v26
  v_add_co_u32 v60, vcc, v60, v26
  s_nop 1
  v_addc_co_u32 v61, vcc, 0, v61, vcc
  global_load_dword v104, v[60:61], off offset:0
  global_load_dword v105, v[60:61], off offset:40
  global_load_dword v106, v[60:61], off offset:80
  global_load_dword v107, v[60:61], off offset:120
  global_load_dword v108, v[60:61], off offset:160
  global_load_dword v109, v[60:61], off offset:200
  global_load_dword v110, v[60:61], off offset:240
  global_load_dword v111, v[60:61], off offset:280
  v_add_co_u32 v60, vcc, 2560, v60
  s_nop 1
  v_addc_co_u32 v61, vcc, 0, v61, vcc
  global_load_dword v112, v[60:61], off offset:0
  global_load_dword v113, v[60:61], off offset:40
  global_load_dword v114, v[60:61], off offset:80
  global_load_dword v115, v[60:61], off offset:120
  global_load_dword v116, v[60:61], off offset:160
  global_load_dword v117, v[60:61], off offset:200
  global_load_dword v118, v[60:61], off offset:240
  global_load_dword v119, v[60:61], off offset:280
  v_cmp_gt_u32 vcc, 4, v3
  v_mov_b32 v25, 2560
  s_nop 0
  v_cndmask_b32 v25, 0, v25, vcc
  v_add_co_u32 v60, vcc, v60, v25
  s_nop 1
  v_addc_co_u32 v61, vcc, 0, v61, vcc
  global_load_dword v120, v[60:61], off offset:0
  global_load_dword v121, v[60:61], off offset:40
  global_load_dword v122, v[60:61], off offset:80
  global_load_dword v123, v[60:61], off offset:120
  global_load_dword v124, v[60:61], off offset:160
  global_load_dword v125, v[60:61], off offset:200
  global_load_dword v126, v[60:61], off offset:240
  global_load_dword v127, v[60:61], off offset:280
L0_nokvld:
  v_lshlrev_b32 v11, 1, v2
  v_add_u32 v11, s19, v11
  v_mul_u32_u24 v12, s26, v11
  v_lshrrev_b32 v12, 16, v12
  v_mul_u32_u24 v15, s27, v12
  v_sub_u32 v15, v11, v15
  v_lshrrev_b32 v13, 4, v15
  v_and_b32 v14, 15, v15
  v_and_b32 v15, 4, v14
  v_and_b32 v16, 8, v14
  v_lshlrev_b32 v15, 1, v15
  v_lshrrev_b32 v16, 1, v16
  v_or_b32 v15, v15, v16
  v_and_b32 v16, 3, v14
  v_or_b32 v15, v15, v16
  s_cmp_eq_u32 s30, 1
  s_cselect_b64 vcc, -1, 0
  v_cndmask_b32 v14, v14, v15, vcc
  v_mul_lo_u32 v17, v12, s28
  v_mul_lo_u32 v15, v13, s29
  v_add_u32 v17, v17, v15
  v_lshl_add_u32 v17, v14, 4, v17
  v_add_u32 v17, s25, v17
  s_lshr_b32 s55, s2, 3
  s_mul_i32 s55, s55, 81920
  s_and_b32 s35, s2, 7
  s_lshl_b32 s35, s35, 7
  s_add_u32 s55, s55, s35
  s_add_u32 s55, s55, 0x662000
  s_lshl_b32 s35, s53, 13
  s_add_u32 s55, s55, s35
  v_lshlrev_b32 v7, 10, v5
  v_lshl_add_u32 v7, v4, 4, v7
  v_add_u32 v9, s54, v7
  v_mov_b32 v18, 0
  v_mov_b32 v19, 0
  v_mov_b32 v27, 0x3f803f80
  s_waitcnt vmcnt(26)
  buffer_store_dwordx4 v[64:67], v7, s[8:11], s55 offen
  s_add_u32 s55, s55, 32768
  v_dot2_f32_bf16 v18, v64, v27, v18
  v_dot2_f32_bf16 v19, v64, v64, v19
  v_dot2_f32_bf16 v18, v65, v27, v18
  v_dot2_f32_bf16 v19, v65, v65, v19
  v_dot2_f32_bf16 v18, v66, v27, v18
  v_dot2_f32_bf16 v19, v66, v66, v19
  v_dot2_f32_bf16 v18, v67, v27, v18
  v_dot2_f32_bf16 v19, v67, v67, v19
  s_waitcnt vmcnt(26)
  buffer_store_dwordx4 v[68:71], v7, s[8:11], s55 offen
  s_add_u32 s55, s55, 32768
  v_dot2_f32_bf16 v18, v68, v27, v18
  v_dot2_f32_bf16 v19, v68, v68, v19
  v_dot2_f32_bf16 v18, v69, v27, v18
  v_dot2_f32_bf16 v19, v69, v69, v19
  v_dot2_f32_bf16 v18, v70, v27, v18
  v_dot2_f32_bf16 v19, v70, v70, v19
  v_dot2_f32_bf16 v18, v71, v27, v18
  v_dot2_f32_bf16 v19, v71, v71, v19
  s_waitcnt vmcnt(26)
  buffer_store_dwordx4 v[72:75], v9, s[8:11], s55 offen
  v_dot2_f32_bf16 v18, v72, v27, v18
  v_dot2_f32_bf16 v19, v72, v72, v19
  v_dot2_f32_bf16 v18, v73, v27, v18
  v_dot2_f32_bf16 v19, v73, v73, v19
  v_dot2_f32_bf16 v18, v74, v27, v18
  v_dot2_f32_bf16 v19, v74, v74, v19
  v_dot2_f32_bf16 v18, v75, v27, v18
  v_dot2_f32_bf16 v19, v75, v75, v19
  s_nop 1
  v_add_f32_dpp v18, v18, v18 row_ror:8 row_mask:0xf bank_mask:0xf
  v_mov_b32 v15, v18
  s_nop 1
  v_permlane16_swap_b32 v18, v15
  v_add_f32 v18, v18, v15
  v_mov_b32 v15, v18
  s_nop 1
  v_permlane32_swap_b32 v18, v15
  v_add_f32 v18, v18, v15
  v_add_f32_dpp v19, v19, v19 row_ror:8 row_mask:0xf bank_mask:0xf
  v_mov_b32 v15, v19
  s_nop 1
  v_permlane16_swap_b32 v19, v15
  v_add_f32 v19, v19, v15
  v_mov_b32 v15, v19
  s_nop 1
  v_permlane32_swap_b32 v19, v15
  v_add_f32 v19, v19, v15
  v_lshlrev_b32 v15, 3, v4
  s_lshl_b32 s35, s53, 6
  v_add_u32 v15, s35, v15
  ds_write_b64 v15, v[18:19] offset:4096
  v_mov_b32 v20, 0
  v_mov_b32 v21, 0
  s_mov_b32 s60, 0x05040100
  s_mov_b32 s61, 0x07060302
  v_add_u32 v22, 0, v3
  v_cmp_gt_u32 vcc, s18, v22
  v_add_u32 v22, s24, v22
  v_lshrrev_b32 v15, s21, v22
  v_mul_lo_u32 v15, v15, s22
  v_and_b32 v16, s52, v22
  v_mul_lo_u32 v16, v16, s23
  v_add3_u32 v23, v17, v15, v16
  v_mov_b32 v15, 0x40000000
  v_cndmask_b32 v23, v15, v23, vcc
  s_waitcnt vmcnt(25)
  v_perm_b32 v28, v81, v80, s60
  v_perm_b32 v32, v81, v80, s61
  s_waitcnt vmcnt(23)
  v_perm_b32 v29, v83, v82, s60
  v_perm_b32 v33, v83, v82, s61
  s_waitcnt vmcnt(21)
  v_perm_b32 v30, v85, v84, s60
  v_perm_b32 v34, v85, v84, s61
  s_waitcnt vmcnt(19)
  v_perm_b32 v31, v87, v86, s60
  v_perm_b32 v35, v87, v86, s61
  v_add_u32 v26, 16, v23
  v_permlane32_swap_b32 v28, v32
  v_permlane32_swap_b32 v29, v33
  v_permlane32_swap_b32 v30, v34
  v_permlane32_swap_b32 v31, v35
  v_permlane32_swap_b32 v23, v26
  buffer_store_dwordx4 v[28:31], v23, s[8:11], 0 offen
  buffer_store_dwordx4 v[32:35], v26, s[8:11], 0 offen
  v_mov_b32 v15, 0x00003f80
  v_mov_b32 v16, 0x3f800000
  v_cndmask_b32 v15, 0, v15, vcc
  v_cndmask_b32 v16, 0, v16, vcc
  v_dot2_f32_bf16 v20, v80, v15, v20
  v_dot2_f32_bf16 v21, v80, v16, v21
  v_dot2_f32_bf16 v20, v81, v15, v20
  v_dot2_f32_bf16 v21, v81, v16, v21
  v_dot2_f32_bf16 v20, v82, v15, v20
  v_dot2_f32_bf16 v21, v82, v16, v21
  v_dot2_f32_bf16 v20, v83, v15, v20
  v_dot2_f32_bf16 v21, v83, v16, v21
  v_dot2_f32_bf16 v20, v84, v15, v20
  v_dot2_f32_bf16 v21, v84, v16, v21
  v_dot2_f32_bf16 v20, v85, v15, v20
  v_dot2_f32_bf16 v21, v85, v16, v21
  v_dot2_f32_bf16 v20, v86, v15, v20
  v_dot2_f32_bf16 v21, v86, v16, v21
  v_dot2_f32_bf16 v20, v87, v15, v20
  v_dot2_f32_bf16 v21, v87, v16, v21
  v_add_u32 v22, 8, v3
  v_cmp_gt_u32 vcc, s18, v22
  v_add_u32 v22, s24, v22
  v_lshrrev_b32 v15, s21, v22
  v_mul_lo_u32 v15, v15, s22
  v_and_b32 v16, s52, v22
  v_mul_lo_u32 v16, v16, s23
  v_add3_u32 v23, v17, v15, v16
  v_mov_b32 v15, 0x40000000
  v_cndmask_b32 v23, v15, v23, vcc
  s_waitcnt vmcnt(19)
  v_perm_b32 v28, v89, v88, s60
  v_perm_b32 v32, v89, v88, s61
  s_waitcnt vmcnt(17)
  v_perm_b32 v29, v91, v90, s60
  v_perm_b32 v33, v91, v90, s61
  s_waitcnt vmcnt(15)
  v_perm_b32 v30, v93, v92, s60
  v_perm_b32 v34, v93, v92, s61
  s_waitcnt vmcnt(13)
  v_perm_b32 v31, v95, v94, s60
  v_perm_b32 v35, v95, v94, s61
  v_add_u32 v26, 16, v23
  v_permlane32_swap_b32 v28, v32
  v_permlane32_swap_b32 v29, v33
  v_permlane32_swap_b32 v30, v34
  v_permlane32_swap_b32 v31, v35
  v_permlane32_swap_b32 v23, v26
  buffer_store_dwordx4 v[28:31], v23, s[8:11], 0 offen
  buffer_store_dwordx4 v[32:35], v26, s[8:11], 0 offen
  v_mov_b32 v15, 0x00003f80
  v_mov_b32 v16, 0x3f800000
  v_cndmask_b32 v15, 0, v15, vcc
  v_cndmask_b32 v16, 0, v16, vcc
  v_dot2_f32_bf16 v20, v88, v15, v20
  v_dot2_f32_bf16 v21, v88, v16, v21
  v_dot2_f32_bf16 v20, v89, v15, v20
  v_dot2_f32_bf16 v21, v89, v16, v21
  v_dot2_f32_bf16 v20, v90, v15, v20
  v_dot2_f32_bf16 v21, v90, v16, v21
  v_dot2_f32_bf16 v20, v91, v15, v20
  v_dot2_f32_bf16 v21, v91, v16, v21
  v_dot2_f32_bf16 v20, v92, v15, v20
  v_dot2_f32_bf16 v21, v92, v16, v21
  v_dot2_f32_bf16 v20, v93, v15, v20
  v_dot2_f32_bf16 v21, v93, v16, v21
  v_dot2_f32_bf16 v20, v94, v15, v20
  v_dot2_f32_bf16 v21, v94, v16, v21
  v_dot2_f32_bf16 v20, v95, v15, v20
  v_dot2_f32_bf16 v21, v95, v16, v21
  v_add_u32 v22, 16, v3
  v_cmp_gt_u32 vcc, s18, v22
  v_add_u32 v22, s24, v22
  v_lshrrev_b32 v15, s21, v22
  v_mul_lo_u32 v15, v15, s22
  v_and_b32 v16, s52, v22
  v_mul_lo_u32 v16, v16, s23
  v_add3_u32 v23, v17, v15, v16
  v_mov_b32 v15, 0x40000000
  v_cndmask_b32 v23, v15, v23, vcc
  s_waitcnt vmcnt(13)
  v_perm_b32 v28, v97, v96, s60
  v_perm_b32 v32, v97, v96, s61
  s_waitcnt vmcnt(11)
  v_perm_b32 v29, v99, v98, s60
  v_perm_b32 v33, v99, v98, s61
  s_waitcnt vmcnt(9)
  v_perm_b32 v30, v101, v100, s60
  v_perm_b32 v34, v101, v100, s61
  s_waitcnt vmcnt(7)
  v_perm_b32 v31, v103, v102, s60
  v_perm_b32 v35, v103, v102, s61
  v_add_u32 v26, 16, v23
  v_permlane32_swap_b32 v28, v32
  v_permlane32_swap_b32 v29, v33
  v_permlane32_swap_b32 v30, v34
  v_permlane32_swap_b32 v31, v35
  v_permlane32_swap_b32 v23, v26
  buffer_store_dwordx4 v[28:31], v23, s[8:11], 0 offen
  buffer_store_dwordx4 v[32:35], v26, s[8:11], 0 offen
  v_mov_b32 v15, 0x00003f80
  v_mov_b32 v16, 0x3f800000
  v_cndmask_b32 v15, 0, v15, vcc
  v_cndmask_b32 v16, 0, v16, vcc
  v_dot2_f32_bf16 v20, v96, v15, v20
  v_dot2_f32_bf16 v21, v96, v16, v21
  v_dot2_f32_bf16 v20, v97, v15, v20
  v_dot2_f32_bf16 v21, v97, v16, v21
  v_dot2_f32_bf16 v20, v98, v15, v20
  v_dot2_f32_bf16 v21, v98, v16, v21
  v_dot2_f32_bf16 v20, v99, v15, v20
  v_dot2_f32_bf16 v21, v99, v16, v21
  v_dot2_f32_bf16 v20, v100, v15, v20
  v_dot2_f32_bf16 v21, v100, v16, v21
  v_dot2_f32_bf16 v20, v101, v15, v20
  v_dot2_f32_bf16 v21, v101, v16, v21
  v_dot2_f32_bf16 v20, v102, v15, v20
  v_dot2_f32_bf16 v21, v102, v16, v21
  v_dot2_f32_bf16 v20, v103, v15, v20
  v_dot2_f32_bf16 v21, v103, v16, v21
  v_lshlrev_b32 v15, 8, v3
  v_lshl_add_u32 v15, v2, 3, v15
  s_nop 0
  ds_write_b64 v15, v[20:21]
  s_cmp_lt_u32 s2, 40
  s_cbranch_scc1 L0_nokv1
  s_cmp_ge_u32 s2, 72
  s_cbranch_scc1 L0_nokv1
  s_waitcnt vmcnt(0)
  v_cmp_le_u32 vcc, 10, v2
  s_nop 1
  v_cndmask_b32 v54, 0, 2, vcc
  v_cndmask_b32 v15, 0, 10, vcc
  v_sub_u32 v52, v2, v15
  v_lshrrev_b32 v53, 1, v52
  v_cmp_le_u32 vcc, 3, v53
  s_nop 1
  v_cndmask_b32 v15, 0, 1, vcc
  v_add_u32 v54, v54, v15
  v_mul_u32_u24 v15, 3, v15
  v_sub_u32 v15, v53, v15
  v_lshlrev_b32 v15, 2, v15
  v_and_b32 v16, 1, v52
  v_lshl_add_u32 v15, v16, 1, v15
  v_add_u32 v55, 20, v15
  v_cmp_gt_u32 s[64:65], 20, v2
  v_mul_u32_u24 v56, 40960, v54
  v_lshl_add_u32 v56, v55, 4, v56
  v_add_u32 v56, 0x90000, v56
  v_mov_b32 v20, 0
  v_mov_b32 v21, 0
  v_add_u32 v22, 0, v3
  v_cmp_gt_u32 vcc, 20, v22
  s_nop 3
  s_and_b64 vcc, vcc, s[64:65]
  v_add_u32 v22, s67, v22
  v_lshrrev_b32 v15, 1, v22
  v_lshlrev_b32 v15, 10, v15
  v_and_b32 v16, 1, v22
  v_lshlrev_b32 v16, 9, v16
  v_add3_u32 v23, v56, v15, v16
  v_mov_b32 v15, 0x40000000
  v_cndmask_b32 v23, v15, v23, vcc
  v_perm_b32 v28, v105, v104, s60
  v_perm_b32 v32, v105, v104, s61
  v_perm_b32 v29, v107, v106, s60
  v_perm_b32 v33, v107, v106, s61
  v_perm_b32 v30, v109, v108, s60
  v_perm_b32 v34, v109, v108, s61
  v_perm_b32 v31, v111, v110, s60
  v_perm_b32 v35, v111, v110, s61
  s_mul_i32 s20, s68, 163840
  buffer_store_dwordx4 v[28:31], v23, s[8:11], s20 offen
  buffer_store_dwordx4 v[32:35], v23, s[8:11], s20 offen offset:16
  v_mov_b32 v15, 0x00003f80
  v_mov_b32 v16, 0x3f800000
  v_cndmask_b32 v15, 0, v15, vcc
  v_cndmask_b32 v16, 0, v16, vcc
  v_dot2_f32_bf16 v20, v104, v15, v20
  v_dot2_f32_bf16 v21, v104, v16, v21
  v_dot2_f32_bf16 v20, v105, v15, v20
  v_dot2_f32_bf16 v21, v105, v16, v21
  v_dot2_f32_bf16 v20, v106, v15, v20
  v_dot2_f32_bf16 v21, v106, v16, v21
  v_dot2_f32_bf16 v20, v107, v15, v20
  v_dot2_f32_bf16 v21, v107, v16, v21
  v_dot2_f32_bf16 v20, v108, v15, v20
  v_dot2_f32_bf16 v21, v108, v16, v21
  v_dot2_f32_bf16 v20, v109, v15, v20
  v_dot2_f32_bf16 v21, v109, v16, v21
  v_dot2_f32_bf16 v20, v110, v15, v20
  v_dot2_f32_bf16 v21, v110, v16, v21
  v_dot2_f32_bf16 v20, v111, v15, v20
  v_dot2_f32_bf16 v21, v111, v16, v21
  v_add_u32 v22, 8, v3
  v_cmp_gt_u32 vcc, 20, v22
  s_nop 3
  s_and_b64 vcc, vcc, s[64:65]
  v_add_u32 v22, s67, v22
  v_lshrrev_b32 v15, 1, v22
  v_lshlrev_b32 v15, 10, v15
  v_and_b32 v16, 1, v22
  v_lshlrev_b32 v16, 9, v16
  v_add3_u32 v23, v56, v15, v16
  v_mov_b32 v15, 0x40000000
  v_cndmask_b32 v23, v15, v23, vcc
  v_perm_b32 v28, v113, v112, s60
  v_perm_b32 v32, v113, v112, s61
  v_perm_b32 v29, v115, v114, s60
  v_perm_b32 v33, v115, v114, s61
  v_perm_b32 v30, v117, v116, s60
  v_perm_b32 v34, v117, v116, s61
  v_perm_b32 v31, v119, v118, s60
  v_perm_b32 v35, v119, v118, s61
  s_mul_i32 s20, s68, 163840
  buffer_store_dwordx4 v[28:31], v23, s[8:11], s20 offen
  buffer_store_dwordx4 v[32:35], v23, s[8:11], s20 offen offset:16
  v_mov_b32 v15, 0x00003f80
  v_mov_b32 v16, 0x3f800000
  v_cndmask_b32 v15, 0, v15, vcc
  v_cndmask_b32 v16, 0, v16, vcc
  v_dot2_f32_bf16 v20, v112, v15, v20
  v_dot2_f32_bf16 v21, v112, v16, v21
  v_dot2_f32_bf16 v20, v113, v15, v20
  v_dot2_f32_bf16 v21, v113, v16, v21
  v_dot2_f32_bf16 v20, v114, v15, v20
  v_dot2_f32_bf16 v21, v114, v16, v21
  v_dot2_f32_bf16 v20, v115, v15, v20
  v_dot2_f32_bf16 v21, v115, v16, v21
  v_dot2_f32_bf16 v20, v116, v15, v20
  v_dot2_f32_bf16 v21, v116, v16, v21
  v_dot2_f32_bf16 v20, v117, v15, v20
  v_dot2_f32_bf16 v21, v117, v16, v21
  v_dot2_f32_bf16 v20, v118, v15, v20
  v_dot2_f32_bf16 v21, v118, v16, v21
  v_dot2_f32_bf16 v20, v119, v15, v20
  v_dot2_f32_bf16 v21, v119, v16, v21
  v_add_u32 v22, 16, v3
  v_cmp_gt_u32 vcc, 20, v22
  s_nop 3
  s_and_b64 vcc, vcc, s[64:65]
  v_add_u32 v22, s67, v22
  v_lshrrev_b32 v15, 1, v22
  v_lshlrev_b32 v15, 10, v15
  v_and_b32 v16, 1, v22
  v_lshlrev_b32 v16, 9, v16
  v_add3_u32 v23, v56, v15, v16
  v_mov_b32 v15, 0x40000000
  v_cndmask_b32 v23, v15, v23, vcc
  v_perm_b32 v28, v121, v120, s60
  v_perm_b32 v32, v121, v120, s61
  v_perm_b32 v29, v123, v122, s60
  v_perm_b32 v33, v123, v122, s61
  v_perm_b32 v30, v125, v124, s60
  v_perm_b32 v34, v125, v124, s61
  v_perm_b32 v31, v127, v126, s60
  v_perm_b32 v35, v127, v126, s61
  s_mul_i32 s20, s68, 163840
  buffer_store_dwordx4 v[28:31], v23, s[8:11], s20 offen
  buffer_store_dwordx4 v[32:35], v23, s[8:11], s20 offen offset:16
  v_mov_b32 v15, 0x00003f80
  v_mov_b32 v16, 0x3f800000
  v_cndmask_b32 v15, 0, v15, vcc
  v_cndmask_b32 v16, 0, v16, vcc
  v_dot2_f32_bf16 v20, v120, v15, v20
  v_dot2_f32_bf16 v21, v120, v16, v21
  v_dot2_f32_bf16 v20, v121, v15, v20
  v_dot2_f32_bf16 v21, v121, v16, v21
  v_dot2_f32_bf16 v20, v122, v15, v20
  v_dot2_f32_bf16 v21, v122, v16, v21
  v_dot2_f32_bf16 v20, v123, v15, v20
  v_dot2_f32_bf16 v21, v123, v16, v21
  v_dot2_f32_bf16 v20, v124, v15, v20
  v_dot2_f32_bf16 v21, v124, v16, v21
  v_dot2_f32_bf16 v20, v125, v15, v20
  v_dot2_f32_bf16 v21, v125, v16, v21
  v_dot2_f32_bf16 v20, v126, v15, v20
  v_dot2_f32_bf16 v21, v126, v16, v21
  v_dot2_f32_bf16 v20, v127, v15, v20
  v_dot2_f32_bf16 v21, v127, v16, v21
  v_lshlrev_b32 v15, 8, v3
  v_lshl_add_u32 v15, v2, 3, v15
  s_nop 0
  ds_write_b64 v15, v[20:21] offset:4608
L0_nokv1:
  s_nop 1
  s_waitcnt lgkmcnt(0)
  s_barrier
  v_cmp_gt_u32 vcc, 64, v0
  s_nop 3
  s_and_saveexec_b64 s[62:63], vcc
  s_cbranch_execz L0_nocs
  v_lshlrev_b32 v15, 3, v4
  ds_read_b64 v[36:37], v15 offset:4096
  ds_read_b64 v[38:39], v15 offset:4160
  ds_read_b64 v[40:41], v15 offset:4224
  ds_read_b64 v[42:43], v15 offset:4288
  s_waitcnt lgkmcnt(2)
  v_add_f32 v36, v36, v38
  s_waitcnt lgkmcnt(0)
  v_add_f32 v40, v40, v42
  v_add_f32 v36, v36, v40
  v_add_f32 v37, v37, v39
  v_add_f32 v41, v41, v43
  v_add_f32 v37, v37, v41
  v_cmp_eq_u32 vcc, 0, v5
  s_nop 1
  v_cndmask_b32 v36, 0, v36, vcc
  v_cndmask_b32 v37, 0, v37, vcc
  s_lshr_b32 s35, s2, 3
  s_lshl_b32 s35, s35, 12
  s_and_b32 s20, s2, 7
  s_lshl_b32 s20, s20, 6
  s_add_u32 s35, s35, s20
  s_add_u32 s35, s35, 0x8e2000
  v_lshlrev_b32 v15, 9, v5
  v_lshl_add_u32 v15, v4, 3, v15
  buffer_store_dwordx2 v[36:37], v15, s[8:11], s35 offen
  s_cmp_eq_u32 s31, 0
  s_cbranch_scc1 L0_nocs
  v_lshlrev_b32 v15, 2, v0
  ds_read_b32 v44, v15 offset:0
  ds_read_b32 v45, v15 offset:256
  ds_read_b32 v46, v15 offset:512
  ds_read_b32 v47, v15 offset:768
  ds_read_b32 v48, v15 offset:1024
  ds_read_b32 v49, v15 offset:1280
  ds_read_b32 v50, v15 offset:1536
  ds_read_b32 v51, v15 offset:1792
  v_add_u32 v11, s19, v0
  v_mul_u32_u24 v12, s26, v11
  v_lshrrev_b32 v12, 16, v12
  v_mul_u32_u24 v15, s27, v12
  v_sub_u32 v15, v11, v15
  v_lshrrev_b32 v13, 4, v15
  v_and_b32 v14, 15, v15
  v_and_b32 v15, 4, v14
  v_and_b32 v16, 8, v14
  v_lshlrev_b32 v15, 1, v15
  v_lshrrev_b32 v16, 1, v16
  v_or_b32 v15, v15, v16
  v_and_b32 v16, 3, v14
  v_or_b32 v15, v15, v16
  s_cmp_eq_u32 s30, 1
  s_cselect_b64 vcc, -1, 0
  v_cndmask_b32 v14, v14, v15, vcc
  s_waitcnt lgkmcnt(6)
  v_add_f32 v44, v44, v45
  s_waitcnt lgkmcnt(5)
  v_add_f32 v44, v44, v46
  s_waitcnt lgkmcnt(4)
  v_add_f32 v44, v44, v47
  s_waitcnt lgkmcnt(3)
  v_add_f32 v44, v44, v48
  s_waitcnt lgkmcnt(2)
  v_add_f32 v44, v44, v49
  s_waitcnt lgkmcnt(1)
  v_add_f32 v44, v44, v50
  s_waitcnt lgkmcnt(0)
  v_add_f32 v44, v44, v51
  v_mul_lo_u32 v23, v12, s33
  v_lshl_add_u32 v23, v13, 6, v23
  v_lshl_add_u32 v23, v14, 2, v23
  buffer_store_dword v44, v23, s[8:11], s32 offen
L0_nocs:
  s_nop 3
  s_mov_b64 exec, -1
  s_cmp_ge_u32 s2, 16
  s_cbranch_scc1 L0_noflag
  v_mov_b32 v28, 0
  v_mov_b32 v29, 0
  v_mov_b32 v30, 0
  v_mov_b32 v31, 0
  v_lshlrev_b32 v15, 4, v0
  s_lshl_b32 s35, s2, 12
  s_add_u32 s35, s35, 0x0
  buffer_store_dwordx4 v[28:31], v15, s[8:11], s35 offen
L0_noflag:
  s_cmp_lt_u32 s2, 40
  s_cbranch_scc1 L0_end
  s_cmp_ge_u32 s2, 72
  s_cbranch_scc1 L0_end
  v_lshlrev_b32 v15, 3, v2
  ds_read_b64 v[36:37], v15 offset:4608
  ds_read_b64 v[38:39], v15 offset:4864
  ds_read_b64 v[40:41], v15 offset:5120
  ds_read_b64 v[42:43], v15 offset:5376
  ds_read_b64 v[44:45], v15 offset:5632
  ds_read_b64 v[46:47], v15 offset:5888
  ds_read_b64 v[48:49], v15 offset:6144
  ds_read_b64 v[50:51], v15 offset:6400
  s_waitcnt lgkmcnt(6)
  v_add_f32 v36, v36, v38
  v_add_f32 v37, v37, v39
  s_waitcnt lgkmcnt(5)
  v_add_f32 v36, v36, v40
  v_add_f32 v37, v37, v41
  s_waitcnt lgkmcnt(4)
  v_add_f32 v36, v36, v42
  v_add_f32 v37, v37, v43
  s_waitcnt lgkmcnt(3)
  v_add_f32 v36, v36, v44
  v_add_f32 v37, v37, v45
  s_waitcnt lgkmcnt(2)
  v_add_f32 v36, v36, v46
  v_add_f32 v37, v37, v47
  s_waitcnt lgkmcnt(1)
  v_add_f32 v36, v36, v48
  v_add_f32 v37, v37, v49
  s_waitcnt lgkmcnt(0)
  v_add_f32 v36, v36, v50
  v_add_f32 v37, v37, v51
  v_lshlrev_b32 v23, 7, v54
  v_lshl_add_u32 v23, v55, 2, v23
  v_cmp_gt_u32 vcc, 20, v0
  v_mov_b32 v15, 0x40000000
  s_nop 0
  v_cndmask_b32 v23, v15, v23, vcc
  s_lshl_b32 s35, s66, 12
  s_add_u32 s35, s35, 0x658000
  s_lshl_b32 s20, s68, 9
  s_add_u32 s35, s35, s20
  buffer_store_dwordx2 v[36:37], v23, s[8:11], s35 offen
L0_end:
  s_endpgm
.globl main_kernel
.p2align 8
.type main_kernel,@function
main_kernel:
  s_cmp_ge_u32 s2, 256
  s_cbranch_scc1 MAIN_END
  s_load_dwordx2 s[4:5], s[0:1], 96
  s_load_dwordx2 s[6:7], s[0:1], 80
  s_load_dwordx2 s[36:37], s[0:1], 56
  s_load_dwordx2 s[38:39], s[0:1], 72
  v_lshrrev_b32 v6, 6, v0
  v_and_b32 v1, 63, v0
  v_readfirstlane_b32 s18, v6
  s_and_b32 s21, s2, 7
  s_lshr_b32 s22, s2, 3
  s_lshl_b32 s16, s21, 2
  s_lshr_b32 s23, s22, 3
  s_add_u32 s16, s16, s23
  s_and_b32 s17, s22, 7
  v_lshlrev_b32 v2, 4, v1
  v_lshrrev_b32 v6, 4, v1
  v_and_b32 v7, 15, v1
  v_lshlrev_b32 v7, 4, v7
  v_lshl_add_u32 v3, v6, 10, v7
  v_lshrrev_b32 v8, 1, v6
  v_lshl_add_u32 v5, v8, 10, v7
  v_and_b32 v8, 1, v6
  v_lshl_add_u32 v5, v8, 3, v5
  v_lshrrev_b32 v6, 5, v1
  v_and_b32 v7, 31, v1
  v_lshlrev_b32 v7, 4, v7
  v_lshl_add_u32 v4, v6, 10, v7
  s_waitcnt lgkmcnt(0)
  s_mov_b32 s8, s4
  s_and_b32 s9, s5, 0xffff
  s_mov_b32 s10, 0x10000000
  s_mov_b32 s11, 0x20000
  s_mov_b32 s12, s6
  s_and_b32 s13, s7, 0xffff
  s_mov_b32 s14, 0x280000
  s_mov_b32 s15, 0x20000
  s_mov_b32 s19, 0
  s_mov_b32 s20, 0
  s_mov_b32 s52, 0
  s_mov_b32 s55, 0
  s_lshl_b32 s53, s16, 8
  s_add_u32 s53, s53, 0x0
  s_mov_b32 s46, 0
  s_lshl_b32 s21, s17, 2
  s_add_u32 s21, s21, s18
  s_mul_i32 s57, s21, 40960
  s_add_u32 s57, s57, 0x90000
  s_mul_i32 s43, s16, 81920
  s_add_u32 s26, s43, 0x662000
  s_mul_i32 s28, s18, 1024
  s_add_u32 s29, s28, 0
  s_add_u32 s28, s28, s26
  s_mov_b32 m0, s29
  s_nop 0
  buffer_load_dwordx4 v2, s[8:11], s28 offen offset:0 sc1 lds
  s_mul_i32 s28, s18, 3072
  s_add_u32 s29, s28, 4096
  s_add_u32 s28, s28, s26
  s_add_u32 s28, s28, 4096
  s_mov_b32 m0, s29
  s_nop 0
  buffer_load_dwordx4 v2, s[8:11], s28 offen offset:0 sc1 lds
  buffer_load_dwordx4 v2, s[8:11], s28 offen offset:1024 sc1 lds
  buffer_load_dwordx4 v2, s[8:11], s28 offen offset:2048 sc1 lds
  s_mul_i32 s28, s18, 4096
  s_add_u32 s29, s28, 16384
  s_add_u32 s28, s28, s26
  s_add_u32 s28, s28, 16384
  s_mov_b32 m0, s29
  s_nop 0
  buffer_load_dwordx4 v2, s[8:11], s28 offen offset:0 sc1 lds
  buffer_load_dwordx4 v2, s[8:11], s28 offen offset:1024 sc1 lds
  buffer_load_dwordx4 v2, s[8:11], s28 offen offset:2048 sc1 lds
  buffer_load_dwordx4 v2, s[8:11], s28 offen offset:3072 sc1 lds
  s_and_b32 s21, s18, 1
  s_lshl_b32 s21, s21, 1
  s_lshr_b32 s22, s18, 1
  s_or_b32 s21, s21, s22
  s_lshl_b32 s21, s21, 8
  s_mul_i32 s22, s17, 10240
  s_add_u32 s21, s21, s22
  s_add_u32 s21, s21, s43
  s_add_u32 s34, s21, 0x662000
  v_lshlrev_b32 v34, 2, v0
  s_lshl_b32 s21, s17, 9
  s_add_u32 s21, s21, 0x658000
  buffer_load_dword v22, v34, s[8:11], s21 offen
  s_add_u32 s21, s21, 4096
  buffer_load_dword v23, v34, s[8:11], s21 offen
  s_add_u32 s21, s21, 4096
  buffer_load_dword v24, v34, s[8:11], s21 offen
  s_add_u32 s21, s21, 4096
  buffer_load_dword v25, v34, s[8:11], s21 offen
  s_mul_i32 s22, s17, 768
  s_add_u32 s21, s22, 0x65c000
  buffer_load_dword v26, v34, s[8:11], s21 offen
  s_add_u32 s21, s21, 6144
  buffer_load_dword v27, v34, s[8:11], s21 offen
  s_add_u32 s21, s21, 6144
  buffer_load_dword v28, v34, s[8:11], s21 offen
  s_add_u32 s21, s21, 6144
  buffer_load_dword v29, v34, s[8:11], s21 offen
  v_lshlrev_b32 v35, 1, v0
  s_mov_b32 s40, s36
  s_and_b32 s41, s37, 0xffff
  s_mov_b32 s42, 0xc00
  s_mov_b32 s43, 0x20000
  s_mul_i32 s22, s17, 384
  buffer_load_ushort v30, v35, s[40:43], s22 offen
  s_mov_b32 s40, s38
  s_and_b32 s41, s39, 0xffff
  s_mov_b32 s42, 0x500
  s_mov_b32 s43, 0x20000
  s_mul_i32 s22, s17, 160
  buffer_load_ushort v31, v35, s[40:43], s22 offen
  s_add_u32 s47, s57, 0
  s_add_u32 s58, s4, s47
  s_addc_u32 s59, s5, 0
  global_load_dwordx4 a[128:131], v2, s[58:59] offset:0
  global_load_dwordx4 a[132:135], v2, s[58:59] offset:1024
  global_load_dwordx4 a[136:139], v2, s[58:59] offset:2048
  global_load_dwordx4 a[140:143], v2, s[58:59] offset:3072
  s_add_u32 s58, s58, 4096
  s_addc_u32 s59, s59, 0
  global_load_dwordx4 a[144:147], v2, s[58:59] offset:0
  global_load_dwordx4 a[148:151], v2, s[58:59] offset:1024
  global_load_dwordx4 a[152:155], v2, s[58:59] offset:2048
  global_load_dwordx4 a[156:159], v2, s[58:59] offset:3072
  s_add_u32 s58, s58, 4096
  s_addc_u32 s59, s59, 0
  global_load_dwordx4 a[160:163], v2, s[58:59] offset:0
  global_load_dwordx4 a[164:167], v2, s[58:59] offset:1024
  global_load_dwordx4 a[168:171], v2, s[58:59] offset:2048
  global_load_dwordx4 a[172:175], v2, s[58:59] offset:3072
  s_add_u32 s58, s58, 4096
  s_addc_u32 s59, s59, 0
  global_load_dwordx4 a[176:179], v2, s[58:59] offset:0
  global_load_dwordx4 a[180:183], v2, s[58:59] offset:1024
  global_load_dwordx4 a[184:187], v2, s[58:59] offset:2048
  global_load_dwordx4 a[188:191], v2, s[58:59] offset:3072
  s_add_u32 s58, s58, 4096
  s_addc_u32 s59, s59, 0
  global_load_dwordx4 a[192:195], v2, s[58:59] offset:0
  global_load_dwordx4 a[196:199], v2, s[58:59] offset:1024
  global_load_dwordx4 a[200:203], v2, s[58:59] offset:2048
  global_load_dwordx4 a[204:207], v2, s[58:59] offset:3072
  buffer_load_dwordx2 v[240:241], v5, s[8:11], s34 offen offset:0 sc1
  buffer_load_dwordx2 v[242:243], v5, s[8:11], s34 offen offset:2048 sc1
  s_add_u32 s34, s34, 4096
  buffer_load_dwordx2 v[244:245], v5, s[8:11], s34 offen offset:0 sc1
  buffer_load_dwordx2 v[246:247], v5, s[8:11], s34 offen offset:2048 sc1
  s_add_u32 s34, s34, 4096
  buffer_load_dwordx2 v[248:249], v5, s[8:11], s34 offen offset:0 sc1
  s_waitcnt vmcnt(33)
  v_add_f32 v22, v22, v23
  s_waitcnt vmcnt(31)
  v_add_f32 v24, v24, v25
  v_add_f32 v22, v22, v24
  s_waitcnt vmcnt(29)
  v_add_f32 v26, v26, v27
  s_waitcnt vmcnt(27)
  v_add_f32 v28, v28, v29
  v_add_f32 v26, v26, v28
  s_waitcnt vmcnt(26)
  v_lshlrev_b32 v30, 16, v30
  s_waitcnt vmcnt(25)
  v_lshlrev_b32 v31, 16, v31
  v_cmp_gt_u32 vcc, 128, v0
  v_mov_b32 v6, 163584
  v_add_u32 v7, 159744, v34
  v_cndmask_b32 v7, v6, v7, vcc
  ds_write_b32 v7, v22
  v_cmp_gt_u32 vcc, 192, v0
  v_mov_b32 v6, 163584
  v_add_u32 v7, 160256, v34
  v_cndmask_b32 v7, v6, v7, vcc
  ds_write_b32 v7, v26
  v_cmp_gt_u32 vcc, 192, v0
  v_mov_b32 v6, 163584
  v_add_u32 v7, 161024, v34
  v_cndmask_b32 v7, v6, v7, vcc
  ds_write_b32 v7, v30
  v_cmp_gt_u32 vcc, 80, v0
  v_mov_b32 v6, 163584
  v_add_u32 v7, 161792, v34
  v_cndmask_b32 v7, v6, v7, vcc
  ds_write_b32 v7, v31
  s_waitcnt lgkmcnt(0)
  s_barrier
  s_lshl_b32 s21, s17, 2
  s_add_u32 s21, s21, s18
  s_mul_i32 s40, s21, 40960
  s_add_u32 s40, s40, 0x90000
  s_mul_i32 s41, s21, 61440
  s_add_u32 s42, s41, 0x478000
  s_add_u32 s41, s41, 0x298000
  s_mul_i32 s43, s16, 81920
  s_branch LAYER_REST
LAYER:
  s_add_u32 s26, s43, 0x662000
  s_mul_i32 s28, s18, 1024
  s_add_u32 s29, s28, 0
  s_add_u32 s28, s28, s26
  s_mov_b32 m0, s29
  s_nop 0
  buffer_load_dwordx4 v2, s[8:11], s28 offen offset:0 sc1 lds
  s_mul_i32 s28, s18, 3072
  s_add_u32 s29, s28, 4096
  s_add_u32 s28, s28, s26
  s_add_u32 s28, s28, 4096
  s_mov_b32 m0, s29
  s_nop 0
  buffer_load_dwordx4 v2, s[8:11], s28 offen offset:0 sc1 lds
  buffer_load_dwordx4 v2, s[8:11], s28 offen offset:1024 sc1 lds
  buffer_load_dwordx4 v2, s[8:11], s28 offen offset:2048 sc1 lds
  s_mul_i32 s28, s18, 4096
  s_add_u32 s29, s28, 16384
  s_add_u32 s28, s28, s26
  s_add_u32 s28, s28, 16384
  s_mov_b32 m0, s29
  s_nop 0
  buffer_load_dwordx4 v2, s[8:11], s28 offen offset:0 sc1 lds
  buffer_load_dwordx4 v2, s[8:11], s28 offen offset:1024 sc1 lds
  buffer_load_dwordx4 v2, s[8:11], s28 offen offset:2048 sc1 lds
  buffer_load_dwordx4 v2, s[8:11], s28 offen offset:3072 sc1 lds
LAYER_REST:
  s_lshl_b32 s27, s16, 12
  s_add_u32 s27, s27, s20
  s_lshl_b32 s21, s18, 10
  s_add_u32 s27, s27, s21
  s_add_u32 s27, s27, 0x8e2000
  v_lshlrev_b32 v30, 3, v1
  s_lshl_b32 s21, s18, 9
  v_add_u32 v31, s21, v30
  v_add_u32 v31, 83968, v31
  buffer_load_dwordx2 v[22:23], v30, s[8:11], s27 offen offset:0 sc1
  buffer_load_dwordx2 v[24:25], v30, s[8:11], s27 offen offset:512 sc1
  v_add_u32 v38, 0, v4
  v_add_u32 v39, 65536, v4
  v_lshrrev_b32 v6, 5, v1
  v_lshlrev_b32 v6, 4, v6
  s_lshl_b32 s21, s18, 7
  v_add_u32 v6, s21, v6
  v_add_u32 v6, 159744, v6
  ds_read_b128 v[128:131], v6 offset:0
  ds_read_b128 v[132:135], v6 offset:32
  ds_read_b128 v[136:139], v6 offset:64
  ds_read_b128 v[140:143], v6 offset:96
  v_and_b32 v58, 31, v1
  v_lshrrev_b32 v59, 5, v1
  s_and_b32 s21, s18, 1
  s_mul_i32 s21, s21, 3
  v_mov_b32 v60, s21
  v_add_u32 v61, 1, v59
  v_add_u32 v61, s21, v61
  s_cmp_ge_u32 s18, 2
  s_cbranch_scc1 QKV_AV_q
  v_lshrrev_b32 v6, 1, v60
  v_lshlrev_b32 v6, 9, v6
  v_and_b32 v7, 1, v60
  v_lshl_add_u32 v6, v7, 3, v6
  v_lshl_add_u32 v6, v58, 4, v6
  v_lshlrev_b32 v7, 3, v58
  v_add_u32 v7, 1024, v7
  v_cmp_eq_u32 vcc, 4, v60
  s_nop 1
  v_cndmask_b32 v6, v6, v7, vcc
  v_add_u32 v6, 102400, v6
  v_cmp_lt_u32 vcc, 4, v60
  v_mov_b32 v7, 163584
  s_nop 0
  v_cndmask_b32 v60, v6, v7, vcc
  v_lshrrev_b32 v6, 1, v61
  v_lshlrev_b32 v6, 9, v6
  v_and_b32 v7, 1, v61
  v_lshl_add_u32 v6, v7, 3, v6
  v_lshl_add_u32 v6, v58, 4, v6
  v_lshlrev_b32 v7, 3, v58
  v_add_u32 v7, 1024, v7
  v_cmp_eq_u32 vcc, 4, v61
  s_nop 1
  v_cndmask_b32 v6, v6, v7, vcc
  v_add_u32 v6, 102400, v6
  v_cmp_lt_u32 vcc, 4, v61
  v_mov_b32 v7, 163584
  s_nop 0
  v_cndmask_b32 v61, v6, v7, vcc
  s_branch QKV_AJ_q
QKV_AV_q:
  v_lshrrev_b32 v6, 4, v58
  v_mul_u32_u24 v6, 768, v6
  v_bfe_u32 v7, v58, 2, 1
  v_mul_u32_u24 v7, 384, v7
  v_add_u32 v6, v6, v7
  v_and_b32 v7, 3, v58
  v_lshl_add_u32 v6, v7, 1, v6
  v_bfe_u32 v7, v58, 3, 1
  v_lshl_add_u32 v6, v7, 3, v6
  v_add_u32 v9, 103936, v6
  v_lshl_add_u32 v6, v60, 6, v9
  v_cmp_lt_u32 vcc, 4, v60
  v_mov_b32 v7, 163584
  s_nop 0
  v_cndmask_b32 v60, v6, v7, vcc
  v_lshl_add_u32 v6, v61, 6, v9
  v_cmp_lt_u32 vcc, 4, v61
  v_mov_b32 v7, 163584
  s_nop 0
  v_cndmask_b32 v61, v6, v7, vcc
  v_and_b32 v6, 3, v1
  v_mul_u32_u24 v6, 384, v6
  v_bfe_u32 v7, v1, 2, 1
  v_mul_u32_u24 v7, 3072, v7
  v_add_u32 v6, v6, v7
  v_add_u32 v6, 104256, v6
  v_mov_b32 v144, 0x3f803f80
  v_mov_b32 v145, 0x3f803f80
  v_mov_b32 v146, 0x3f803f80
  v_mov_b32 v147, 0x3f803f80
  ds_write_b128 v6, v[144:147]
  v_lshlrev_b32 v6, 3, v58
  v_mul_u32_u24 v7, 3072, v59
  v_add_u32 v6, v6, v7
  v_add_u32 v6, 103680, v6
  v_mov_b32 v148, 0x3f803f80
  v_mov_b32 v149, 0x00003f80
  ds_write_b64 v6, v[148:149]
QKV_AJ_q:
  s_nop 0
  v_cmp_gt_u32 vcc, 32, v1
  v_mov_b32 v7, 163584
  s_nop 0
  v_cndmask_b32 v60, v60, v7, vcc
  v_add_u32 v6, 3072, v60
  v_cmp_eq_u32 vcc, v60, v7
  s_nop 1
  v_cndmask_b32 v62, v6, v60, vcc
  v_add_u32 v6, 3072, v61
  v_cmp_eq_u32 vcc, v61, v7
  s_nop 1
  v_cndmask_b32 v63, v6, v61, vcc
  s_waitcnt vmcnt(9)
  s_barrier
  ds_read_b128 v[96:99], v38 offset:0
  ds_read_b128 v[100:103], v38 offset:512
  ds_read_b128 v[104:107], v38 offset:2048
  ds_read_b128 v[108:111], v38 offset:2560
  s_waitcnt vmcnt(6)
  s_barrier
  s_waitcnt lgkmcnt(2)
  v_mfma_f32_32x32x16_bf16 v[64:79], a[128:131], v[96:99], 0
  ds_read_b128 v[112:115], v38 offset:4096
  v_accvgpr_write_b32 a32, 0
  v_accvgpr_write_b32 a33, 0
  v_mfma_f32_32x32x16_bf16 v[80:95], a[128:131], v[100:103], 0
  ds_read_b128 v[116:119], v38 offset:4608
  s_add_u32 s28, s28, 16384
  s_add_u32 s29, s29, 16384
  s_mov_b32 m0, s29
  s_nop 0
  buffer_load_dwordx4 v2, s[8:11], s28 offen offset:0 sc1 lds
  s_waitcnt lgkmcnt(2)
  v_mfma_f32_32x32x16_bf16 v[64:79], a[132:135], v[104:107], v[64:79]
  ds_read_b128 v[120:123], v38 offset:6144
  buffer_load_dwordx4 v2, s[8:11], s28 offen offset:1024 sc1 lds
  v_mfma_f32_32x32x16_bf16 v[80:95], a[132:135], v[108:111], v[80:95]
  ds_read_b128 v[124:127], v38 offset:6656
  buffer_load_dwordx4 v2, s[8:11], s28 offen offset:2048 sc1 lds
  s_waitcnt lgkmcnt(2)
  v_mfma_f32_32x32x16_bf16 v[64:79], a[136:139], v[112:115], v[64:79]
  ds_read_b128 v[96:99], v38 offset:8192
  v_accvgpr_write_b32 a34, 0
  v_accvgpr_write_b32 a35, 0
  v_mfma_f32_32x32x16_bf16 v[80:95], a[136:139], v[116:119], v[80:95]
  ds_read_b128 v[100:103], v38 offset:8704
  buffer_load_dwordx4 v2, s[8:11], s28 offen offset:3072 sc1 lds
  s_waitcnt lgkmcnt(2)
  v_mfma_f32_32x32x16_bf16 v[64:79], a[140:143], v[120:123], v[64:79]
  ds_read_b128 v[104:107], v38 offset:10240
  s_add_u32 s47, s40, 20480
  s_add_u32 s58, s4, s47
  s_addc_u32 s59, s5, 0
  global_load_dwordx4 a[208:211], v2, s[58:59] offset:0
  v_mfma_f32_32x32x16_bf16 v[80:95], a[140:143], v[124:127], v[80:95]
  ds_read_b128 v[108:111], v38 offset:10752
  global_load_dwordx4 a[212:215], v2, s[58:59] offset:1024
  s_waitcnt lgkmcnt(2)
  v_mfma_f32_32x32x16_bf16 v[64:79], a[144:147], v[96:99], v[64:79]
  ds_read_b128 v[112:115], v38 offset:12288
  v_accvgpr_write_b32 a36, 0
  v_accvgpr_write_b32 a37, 0
  v_mfma_f32_32x32x16_bf16 v[80:95], a[144:147], v[100:103], v[80:95]
  ds_read_b128 v[116:119], v38 offset:12800
  global_load_dwordx4 a[216:219], v2, s[58:59] offset:2048
  s_waitcnt lgkmcnt(2)
  v_mfma_f32_32x32x16_bf16 v[64:79], a[148:151], v[104:107], v[64:79]
  ds_read_b128 v[120:123], v38 offset:14336
  global_load_dwordx4 a[220:223], v2, s[58:59] offset:3072
  v_mfma_f32_32x32x16_bf16 v[80:95], a[148:151], v[108:111], v[80:95]
  ds_read_b128 v[124:127], v38 offset:14848
  v_accvgpr_write_b32 a38, 0
  v_accvgpr_write_b32 a39, 0
  s_waitcnt vmcnt(10)
  s_barrier
  s_waitcnt lgkmcnt(2)
  v_mfma_f32_32x32x16_bf16 v[64:79], a[152:155], v[112:115], v[64:79]
  ds_read_b128 v[96:99], v38 offset:16384
  v_accvgpr_write_b32 a40, 0
  v_accvgpr_write_b32 a41, 0
  v_mfma_f32_32x32x16_bf16 v[80:95], a[152:155], v[116:119], v[80:95]
  ds_read_b128 v[100:103], v38 offset:16896
  v_accvgpr_write_b32 a42, 0
  v_accvgpr_write_b32 a43, 0
  s_waitcnt lgkmcnt(2)
  v_mfma_f32_32x32x16_bf16 v[64:79], a[156:159], v[120:123], v[64:79]
  ds_read_b128 v[104:107], v38 offset:18432
  v_accvgpr_write_b32 a44, 0
  v_accvgpr_write_b32 a45, 0
  v_mfma_f32_32x32x16_bf16 v[80:95], a[156:159], v[124:127], v[80:95]
  ds_read_b128 v[108:111], v38 offset:18944
  v_accvgpr_write_b32 a46, 0
  v_accvgpr_write_b32 a47, 0
  s_waitcnt lgkmcnt(2)
  v_mfma_f32_32x32x16_bf16 v[64:79], a[160:163], v[96:99], v[64:79]
  ds_read_b128 v[112:115], v38 offset:20480
  v_accvgpr_write_b32 a48, 0
  v_accvgpr_write_b32 a49, 0
  v_mfma_f32_32x32x16_bf16 v[80:95], a[160:163], v[100:103], v[80:95]
  ds_read_b128 v[116:119], v38 offset:20992
  s_waitcnt vmcnt(8)
  v_pk_add_f32 v[22:23], v[22:23], v[24:25]
  ds_write_b64 v31, v[22:23]
  v_add_u32 v30, 83968, v30
  s_waitcnt lgkmcnt(3)
  v_mfma_f32_32x32x16_bf16 v[64:79], a[164:167], v[104:107], v[64:79]
  ds_read_b128 v[120:123], v38 offset:22528
  s_add_u32 s47, s40, 24576
  s_add_u32 s58, s4, s47
  s_addc_u32 s59, s5, 0
  global_load_dwordx4 a[224:227], v2, s[58:59] offset:0
  v_mfma_f32_32x32x16_bf16 v[80:95], a[164:167], v[108:111], v[80:95]
  ds_read_b128 v[124:127], v38 offset:23040
  global_load_dwordx4 a[228:231], v2, s[58:59] offset:1024
  s_waitcnt lgkmcnt(3)
  v_mfma_f32_32x32x16_bf16 v[64:79], a[168:171], v[112:115], v[64:79]
  ds_read_b128 v[96:99], v38 offset:24576
  v_accvgpr_write_b32 a50, 0
  v_accvgpr_write_b32 a51, 0
  v_mfma_f32_32x32x16_bf16 v[80:95], a[168:171], v[116:119], v[80:95]
  ds_read_b128 v[100:103], v38 offset:25088
  global_load_dwordx4 a[232:235], v2, s[58:59] offset:2048
  s_waitcnt lgkmcnt(2)
  v_mfma_f32_32x32x16_bf16 v[64:79], a[172:175], v[120:123], v[64:79]
  ds_read_b128 v[104:107], v38 offset:26624
  global_load_dwordx4 a[236:239], v2, s[58:59] offset:3072
  v_mfma_f32_32x32x16_bf16 v[80:95], a[172:175], v[124:127], v[80:95]
  ds_read_b128 v[108:111], v38 offset:27136
  s_add_u32 s28, s28, 16384
  s_add_u32 s29, s29, 16384
  s_mov_b32 m0, s29
  s_nop 0
  buffer_load_dwordx4 v2, s[8:11], s28 offen offset:0 sc1 lds
  s_waitcnt lgkmcnt(2)
  v_mfma_f32_32x32x16_bf16 v[64:79], a[176:179], v[96:99], v[64:79]
  ds_read_b128 v[112:115], v38 offset:28672
  v_accvgpr_write_b32 a52, 0
  v_accvgpr_write_b32 a53, 0
  v_mfma_f32_32x32x16_bf16 v[80:95], a[176:179], v[100:103], v[80:95]
  ds_read_b128 v[116:119], v38 offset:29184
  buffer_load_dwordx4 v2, s[8:11], s28 offen offset:1024 sc1 lds
  s_waitcnt lgkmcnt(2)
  v_mfma_f32_32x32x16_bf16 v[64:79], a[180:183], v[104:107], v[64:79]
  ds_read_b128 v[120:123], v38 offset:30720
  buffer_load_dwordx4 v2, s[8:11], s28 offen offset:2048 sc1 lds
  v_mfma_f32_32x32x16_bf16 v[80:95], a[180:183], v[108:111], v[80:95]
  ds_read_b128 v[124:127], v38 offset:31232
  buffer_load_dwordx4 v2, s[8:11], s28 offen offset:3072 sc1 lds
  s_waitcnt vmcnt(12)
  s_barrier
  s_waitcnt lgkmcnt(2)
  v_mfma_f32_32x32x16_bf16 v[64:79], a[184:187], v[112:115], v[64:79]
  ds_read_b128 v[96:99], v38 offset:32768
  v_accvgpr_write_b32 a54, 0
  v_accvgpr_write_b32 a55, 0
  v_mfma_f32_32x32x16_bf16 v[80:95], a[184:187], v[116:119], v[80:95]
  ds_read_b128 v[100:103], v38 offset:33280
  v_accvgpr_write_b32 a56, 0
  v_accvgpr_write_b32 a57, 0
  s_waitcnt lgkmcnt(2)
  v_mfma_f32_32x32x16_bf16 v[64:79], a[188:191], v[120:123], v[64:79]
  ds_read_b128 v[104:107], v38 offset:34816
  v_accvgpr_write_b32 a58, 0
  v_accvgpr_write_b32 a59, 0
  v_mfma_f32_32x32x16_bf16 v[80:95], a[188:191], v[124:127], v[80:95]
  ds_read_b128 v[108:111], v38 offset:35328
  v_accvgpr_write_b32 a60, 0
  v_accvgpr_write_b32 a61, 0
  s_waitcnt lgkmcnt(2)
  v_mfma_f32_32x32x16_bf16 v[64:79], a[192:195], v[96:99], v[64:79]
  ds_read_b128 v[112:115], v38 offset:36864
  v_accvgpr_write_b32 a62, 0
  v_accvgpr_write_b32 a63, 0
  v_mfma_f32_32x32x16_bf16 v[80:95], a[192:195], v[100:103], v[80:95]
  ds_read_b128 v[116:119], v38 offset:37376
  s_add_u32 s28, s28, 16384
  s_add_u32 s29, s29, 16384
  s_mov_b32 m0, s29
  s_nop 0
  buffer_load_dwordx4 v2, s[8:11], s28 offen offset:0 sc1 lds
  s_waitcnt lgkmcnt(2)
  v_mfma_f32_32x32x16_bf16 v[64:79], a[196:199], v[104:107], v[64:79]
  ds_read_b128 v[120:123], v38 offset:38912
  buffer_load_dwordx4 v2, s[8:11], s28 offen offset:1024 sc1 lds
  v_mfma_f32_32x32x16_bf16 v[80:95], a[196:199], v[108:111], v[80:95]
  ds_read_b128 v[124:127], v38 offset:39424
  buffer_load_dwordx4 v2, s[8:11], s28 offen offset:2048 sc1 lds
  s_waitcnt lgkmcnt(2)
  v_mfma_f32_32x32x16_bf16 v[64:79], a[200:203], v[112:115], v[64:79]
  ds_read_b128 v[96:99], v38 offset:40960
  v_accvgpr_write_b32 a64, 0
  v_accvgpr_write_b32 a65, 0
  v_mfma_f32_32x32x16_bf16 v[80:95], a[200:203], v[116:119], v[80:95]
  ds_read_b128 v[100:103], v38 offset:41472
  buffer_load_dwordx4 v2, s[8:11], s28 offen offset:3072 sc1 lds
  s_waitcnt lgkmcnt(2)
  v_mfma_f32_32x32x16_bf16 v[64:79], a[204:207], v[120:123], v[64:79]
  ds_read_b128 v[104:107], v38 offset:43008
  s_add_u32 s47, s40, 28672
  s_add_u32 s58, s4, s47
  s_addc_u32 s59, s5, 0
  global_load_dwordx4 a[240:243], v2, s[58:59] offset:0
  v_mfma_f32_32x32x16_bf16 v[80:95], a[204:207], v[124:127], v[80:95]
  ds_read_b128 v[108:111], v38 offset:43520
  global_load_dwordx4 a[244:247], v2, s[58:59] offset:1024
  s_waitcnt vmcnt(17) lgkmcnt(2)
  v_mfma_f32_32x32x16_bf16 v[64:79], a[208:211], v[96:99], v[64:79]
  ds_read_b128 v[112:115], v38 offset:45056
  v_accvgpr_write_b32 a66, 0
  v_accvgpr_write_b32 a67, 0
  v_mfma_f32_32x32x16_bf16 v[80:95], a[208:211], v[100:103], v[80:95]
  ds_read_b128 v[116:119], v38 offset:45568
  global_load_dwordx4 a[248:251], v2, s[58:59] offset:2048
  s_waitcnt vmcnt(17) lgkmcnt(2)
  v_mfma_f32_32x32x16_bf16 v[64:79], a[212:215], v[104:107], v[64:79]
  ds_read_b128 v[120:123], v38 offset:47104
  global_load_dwordx4 a[252:255], v2, s[58:59] offset:3072
  v_mfma_f32_32x32x16_bf16 v[80:95], a[212:215], v[108:111], v[80:95]
  ds_read_b128 v[124:127], v38 offset:47616
  s_add_u32 s58, s58, 4096
  s_addc_u32 s59, s59, 0
  global_load_dwordx4 a[0:3], v2, s[58:59] offset:0
  s_waitcnt vmcnt(9)
  s_barrier
  s_waitcnt lgkmcnt(2)
  v_mfma_f32_32x32x16_bf16 v[64:79], a[216:219], v[112:115], v[64:79]
  ds_read_b128 v[96:99], v38 offset:49152
  v_accvgpr_write_b32 a68, 0
  v_accvgpr_write_b32 a69, 0
  v_mfma_f32_32x32x16_bf16 v[80:95], a[216:219], v[116:119], v[80:95]
  ds_read_b128 v[100:103], v38 offset:49664
  global_load_dwordx4 a[4:7], v2, s[58:59] offset:1024
  s_waitcnt lgkmcnt(2)
  v_mfma_f32_32x32x16_bf16 v[64:79], a[220:223], v[120:123], v[64:79]
  ds_read_b128 v[104:107], v38 offset:51200
  v_accvgpr_write_b32 a70, 0
  v_accvgpr_write_b32 a71, 0
  v_mfma_f32_32x32x16_bf16 v[80:95], a[220:223], v[124:127], v[80:95]
  ds_read_b128 v[108:111], v38 offset:51712
  v_accvgpr_write_b32 a72, 0
  v_accvgpr_write_b32 a73, 0
  s_waitcnt lgkmcnt(2)
  v_mfma_f32_32x32x16_bf16 v[64:79], a[224:227], v[96:99], v[64:79]
  ds_read_b128 v[112:115], v38 offset:53248
  v_accvgpr_write_b32 a74, 0
  v_accvgpr_write_b32 a75, 0
  v_mfma_f32_32x32x16_bf16 v[80:95], a[224:227], v[100:103], v[80:95]
  ds_read_b128 v[116:119], v38 offset:53760
  s_add_u32 s47, s40, 32768
  s_add_u32 s58, s4, s47
  s_addc_u32 s59, s5, 0
  global_load_dwordx4 a[8:11], v2, s[58:59] offset:2048
  ds_read_b64 v[22:23], v30 offset:0
  s_waitcnt lgkmcnt(3)
  v_mfma_f32_32x32x16_bf16 v[64:79], a[228:231], v[104:107], v[64:79]
  ds_read_b128 v[120:123], v38 offset:55296
  global_load_dwordx4 a[12:15], v2, s[58:59] offset:3072
  ds_read_b64 v[24:25], v30 offset:512
  v_mfma_f32_32x32x16_bf16 v[80:95], a[228:231], v[108:111], v[80:95]
  ds_read_b128 v[124:127], v38 offset:55808
  s_add_u32 s58, s58, 4096
  s_addc_u32 s59, s59, 0
  global_load_dwordx4 a[16:19], v2, s[58:59] offset:0
  s_waitcnt lgkmcnt(4)
  v_mfma_f32_32x32x16_bf16 v[64:79], a[232:235], v[112:115], v[64:79]
  ds_read_b128 v[96:99], v38 offset:57344
  v_accvgpr_write_b32 a76, 0
  v_accvgpr_write_b32 a77, 0
  ds_read_b64 v[26:27], v30 offset:1024
  v_mfma_f32_32x32x16_bf16 v[80:95], a[232:235], v[116:119], v[80:95]
  ds_read_b128 v[100:103], v38 offset:57856
  global_load_dwordx4 a[20:23], v2, s[58:59] offset:1024
  ds_read_b64 v[28:29], v30 offset:1536
  s_waitcnt lgkmcnt(4)
  v_mfma_f32_32x32x16_bf16 v[64:79], a[236:239], v[120:123], v[64:79]
  ds_read_b128 v[104:107], v38 offset:59392
  global_load_dwordx4 a[24:27], v2, s[58:59] offset:2048
  v_mfma_f32_32x32x16_bf16 v[80:95], a[236:239], v[124:127], v[80:95]
  ds_read_b128 v[108:111], v38 offset:59904
  global_load_dwordx4 a[28:31], v2, s[58:59] offset:3072
  s_waitcnt vmcnt(11) lgkmcnt(3)
  v_mfma_f32_32x32x16_bf16 v[64:79], a[240:243], v[96:99], v[64:79]
  ds_read_b128 v[112:115], v38 offset:61440
  v_accvgpr_write_b32 a78, 0
  v_accvgpr_write_b32 a79, 0
  v_mfma_f32_32x32x16_bf16 v[80:95], a[240:243], v[100:103], v[80:95]
  ds_read_b128 v[116:119], v38 offset:61952
  v_accvgpr_write_b32 a80, 0
  v_accvgpr_write_b32 a81, 0
  s_waitcnt vmcnt(10) lgkmcnt(2)
  v_mfma_f32_32x32x16_bf16 v[64:79], a[244:247], v[104:107], v[64:79]
  ds_read_b128 v[120:123], v38 offset:63488
  v_accvgpr_write_b32 a82, 0
  v_accvgpr_write_b32 a83, 0
  v_mfma_f32_32x32x16_bf16 v[80:95], a[244:247], v[108:111], v[80:95]
  ds_read_b128 v[124:127], v38 offset:64000
  v_accvgpr_write_b32 a84, 0
  v_accvgpr_write_b32 a85, 0
  s_barrier
  s_waitcnt vmcnt(9) lgkmcnt(2)
  v_mfma_f32_32x32x16_bf16 v[64:79], a[248:251], v[112:115], v[64:79]
  ds_read_b128 v[96:99], v39 offset:0
  v_accvgpr_write_b32 a86, 0
  v_accvgpr_write_b32 a87, 0
  v_mfma_f32_32x32x16_bf16 v[80:95], a[248:251], v[116:119], v[80:95]
  ds_read_b128 v[100:103], v39 offset:512
  v_accvgpr_write_b32 a88, 0
  v_accvgpr_write_b32 a89, 0
  v_pk_add_f32 v[22:23], v[22:23], v[24:25]
  s_waitcnt vmcnt(8) lgkmcnt(2)
  v_mfma_f32_32x32x16_bf16 v[64:79], a[252:255], v[120:123], v[64:79]
  ds_read_b128 v[104:107], v39 offset:2048
  v_accvgpr_write_b32 a90, 0
  v_accvgpr_write_b32 a91, 0
  v_pk_add_f32 v[26:27], v[26:27], v[28:29]
  v_pk_add_f32 v[22:23], v[22:23], v[26:27]
  v_mfma_f32_32x32x16_bf16 v[80:95], a[252:255], v[124:127], v[80:95]
  ds_read_b128 v[108:111], v39 offset:2560
  v_accvgpr_write_b32 a92, 0
  v_accvgpr_write_b32 a93, 0
  v_mul_f32 v40, 0x3acccccd, v22
  v_mul_f32 v41, 0x3acccccd, v23
  s_waitcnt vmcnt(7) lgkmcnt(2)
  v_mfma_f32_32x32x16_bf16 v[64:79], a[0:3], v[96:99], v[64:79]
  ds_read_b128 v[112:115], v39 offset:4096
  v_accvgpr_write_b32 a94, 0
  v_accvgpr_write_b32 a95, 0
  v_fma_f32 v41, -v40, v40, v41
  v_max_f32 v41, 0, v41
  v_mfma_f32_32x32x16_bf16 v[80:95], a[0:3], v[100:103], v[80:95]
  ds_read_b128 v[116:119], v39 offset:4608
  v_accvgpr_write_b32 a96, 0
  v_accvgpr_write_b32 a97, 0
  v_add_f32 v41, 0x3727c5ac, v41
  s_waitcnt vmcnt(6) lgkmcnt(2)
  v_mfma_f32_32x32x16_bf16 v[64:79], a[4:7], v[104:107], v[64:79]
  ds_read_b128 v[120:123], v39 offset:6144
  v_accvgpr_write_b32 a98, 0
  v_accvgpr_write_b32 a99, 0
  v_rsq_f32 v41, v41
  v_mov_b32 v42, v40
  v_mfma_f32_32x32x16_bf16 v[80:95], a[4:7], v[108:111], v[80:95]
  ds_read_b128 v[124:127], v39 offset:6656
  v_accvgpr_write_b32 a100, 0
  v_accvgpr_write_b32 a101, 0
  v_mov_b32 v44, v40
  v_mov_b32 v46, v41
  s_waitcnt vmcnt(5) lgkmcnt(2)
  v_mfma_f32_32x32x16_bf16 v[64:79], a[8:11], v[112:115], v[64:79]
  ds_read_b128 v[96:99], v39 offset:8192
  v_accvgpr_write_b32 a102, 0
  v_accvgpr_write_b32 a103, 0
  v_mov_b32 v48, v41
  v_permlane32_swap_b32 v42, v44
  v_mfma_f32_32x32x16_bf16 v[80:95], a[8:11], v[116:119], v[80:95]
  ds_read_b128 v[100:103], v39 offset:8704
  v_accvgpr_write_b32 a104, 0
  v_accvgpr_write_b32 a105, 0
  v_permlane32_swap_b32 v46, v48
  s_mov_b32 s30, 0x3ea52b5c
  s_waitcnt vmcnt(4) lgkmcnt(2)
  v_mfma_f32_32x32x16_bf16 v[64:79], a[12:15], v[120:123], v[64:79]
  ds_read_b128 v[104:107], v39 offset:10240
  v_accvgpr_write_b32 a106, 0
  v_accvgpr_write_b32 a107, 0
  v_cmp_gt_u32 s[48:49], 32, v1
  v_mul_f32 v50, s30, v46
  v_mfma_f32_32x32x16_bf16 v[80:95], a[12:15], v[124:127], v[80:95]
  ds_read_b128 v[108:111], v39 offset:10752
  v_accvgpr_write_b32 a108, 0
  v_accvgpr_write_b32 a109, 0
  v_cndmask_b32 v54, v46, v50, s[48:49]
  v_mul_f32 v52, s30, v48
  s_waitcnt vmcnt(3) lgkmcnt(2)
  v_mfma_f32_32x32x16_bf16 v[64:79], a[16:19], v[96:99], v[64:79]
  ds_read_b128 v[112:115], v39 offset:12288
  v_accvgpr_write_b32 a110, 0
  v_accvgpr_write_b32 a111, 0
  v_cndmask_b32 v56, v48, v52, s[48:49]
  v_mfma_f32_32x32x16_bf16 v[80:95], a[16:19], v[100:103], v[80:95]
  ds_read_b128 v[116:119], v39 offset:12800
  v_accvgpr_write_b32 a112, 0
  v_accvgpr_write_b32 a113, 0
  s_waitcnt vmcnt(2) lgkmcnt(2)
  v_mfma_f32_32x32x16_bf16 v[64:79], a[20:23], v[104:107], v[64:79]
  ds_read_b128 v[120:123], v39 offset:14336
  v_accvgpr_write_b32 a114, 0
  v_accvgpr_write_b32 a115, 0
  v_mfma_f32_32x32x16_bf16 v[80:95], a[20:23], v[108:111], v[80:95]
  ds_read_b128 v[124:127], v39 offset:14848
  v_accvgpr_write_b32 a116, 0
  v_accvgpr_write_b32 a117, 0
  s_waitcnt vmcnt(1) lgkmcnt(2)
  v_mfma_f32_32x32x16_bf16 v[64:79], a[24:27], v[112:115], v[64:79]
  v_accvgpr_write_b32 a118, 0
  v_accvgpr_write_b32 a119, 0
  v_mfma_f32_32x32x16_bf16 v[80:95], a[24:27], v[116:119], v[80:95]
  v_accvgpr_write_b32 a120, 0
  v_accvgpr_write_b32 a121, 0
  s_waitcnt vmcnt(0) lgkmcnt(0)
  v_mfma_f32_32x32x16_bf16 v[64:79], a[28:31], v[120:123], v[64:79]
  v_accvgpr_write_b32 a122, 0
  v_accvgpr_write_b32 a123, 0
  v_mfma_f32_32x32x16_bf16 v[80:95], a[28:31], v[124:127], v[80:95]
  v_accvgpr_write_b32 a124, 0
  v_accvgpr_write_b32 a125, 0
  v_accvgpr_write_b32 a126, 0
  v_accvgpr_write_b32 a127, 0
  s_nop 4
  v_pk_fma_f32 v[72:73], v[42:43], v[136:137], v[72:73] op_sel_hi:[0,1,1] neg_lo:[1,0,0] neg_hi:[1,0,0]
  v_pk_fma_f32 v[74:75], v[42:43], v[138:139], v[74:75] op_sel_hi:[0,1,1] neg_lo:[1,0,0] neg_hi:[1,0,0]
  v_pk_fma_f32 v[76:77], v[42:43], v[140:141], v[76:77] op_sel_hi:[0,1,1] neg_lo:[1,0,0] neg_hi:[1,0,0]
  v_pk_fma_f32 v[78:79], v[42:43], v[142:143], v[78:79] op_sel_hi:[0,1,1] neg_lo:[1,0,0] neg_hi:[1,0,0]
  v_pk_mul_f32 v[72:73], v[72:73], v[54:55] op_sel_hi:[1,0]
  v_pk_mul_f32 v[74:75], v[74:75], v[54:55] op_sel_hi:[1,0]
  v_pk_mul_f32 v[76:77], v[76:77], v[46:47] op_sel_hi:[1,0]
  v_pk_mul_f32 v[78:79], v[78:79], v[46:47] op_sel_hi:[1,0]
  v_cvt_pk_bf16_f32 v14, v72, v73
  v_cvt_pk_bf16_f32 v15, v74, v75
  v_cvt_pk_bf16_f32 v152, v76, v77
  v_cvt_pk_bf16_f32 v153, v78, v79
  v_pk_fma_f32 v[88:89], v[44:45], v[136:137], v[88:89] op_sel_hi:[0,1,1] neg_lo:[1,0,0] neg_hi:[1,0,0]
  v_pk_fma_f32 v[90:91], v[44:45], v[138:139], v[90:91] op_sel_hi:[0,1,1] neg_lo:[1,0,0] neg_hi:[1,0,0]
  v_pk_fma_f32 v[92:93], v[44:45], v[140:141], v[92:93] op_sel_hi:[0,1,1] neg_lo:[1,0,0] neg_hi:[1,0,0]
  v_pk_fma_f32 v[94:95], v[44:45], v[142:143], v[94:95] op_sel_hi:[0,1,1] neg_lo:[1,0,0] neg_hi:[1,0,0]
  v_pk_mul_f32 v[88:89], v[88:89], v[56:57] op_sel_hi:[1,0]
  v_pk_mul_f32 v[90:91], v[90:91], v[56:57] op_sel_hi:[1,0]
  v_pk_mul_f32 v[92:93], v[92:93], v[48:49] op_sel_hi:[1,0]
  v_pk_mul_f32 v[94:95], v[94:95], v[48:49] op_sel_hi:[1,0]
  v_cvt_pk_bf16_f32 v20, v88, v89
  v_cvt_pk_bf16_f32 v21, v90, v91
  v_cvt_pk_bf16_f32 v154, v92, v93
  v_cvt_pk_bf16_f32 v155, v94, v95
  s_cmp_ge_u32 s18, 2
  s_cbranch_scc1 QKV_V_q
  ds_write_b64 v60, v[14:15]
  ds_write_b64 v61, v[152:153]
  ds_write_b64 v62, v[20:21]
  ds_write_b64 v63, v[154:155]
  s_branch QKV_J_q
QKV_V_q:
  ds_write_b16 v60, v14 offset:0
  ds_write_b16_d16_hi v60, v14 offset:16
  ds_write_b16 v60, v15 offset:32
  ds_write_b16_d16_hi v60, v15 offset:48
  ds_write_b16 v61, v152 offset:0
  ds_write_b16_d16_hi v61, v152 offset:16
  ds_write_b16 v61, v153 offset:32
  ds_write_b16_d16_hi v61, v153 offset:48
  ds_write_b16 v62, v20 offset:0
  ds_write_b16_d16_hi v62, v20 offset:16
  ds_write_b16 v62, v21 offset:32
  ds_write_b16_d16_hi v62, v21 offset:48
  ds_write_b16 v63, v154 offset:0
  ds_write_b16_d16_hi v63, v154 offset:16
  ds_write_b16 v63, v155 offset:32
  ds_write_b16_d16_hi v63, v155 offset:48
QKV_J_q:
  s_mul_i32 s21, s17, 768
  v_add_u32 v6, s21, v2
  v_add_u32 v8, 102400, v6
  s_cmp_eq_u32 s18, 0
  s_cselect_b32 s22, 48, 0
  v_cmp_gt_u32 vcc, s22, v1
  v_mov_b32 v7, 0x40000000
  s_nop 0
  v_cndmask_b32 v6, v7, v6, vcc
  s_mul_i32 s21, s16, 6144
  s_add_u32 s21, s21, s20
  s_add_u32 s21, s21, 0x902000
  s_waitcnt lgkmcnt(0)
  s_barrier
  ds_read_b128 v[144:147], v8
  s_waitcnt lgkmcnt(0)
  buffer_store_dwordx4 v[144:147], v6, s[8:11], s21 offen sc1
  v_pk_fma_f32 v[64:65], v[42:43], v[128:129], v[64:65] op_sel_hi:[0,1,1] neg_lo:[1,0,0] neg_hi:[1,0,0]
  v_pk_fma_f32 v[66:67], v[42:43], v[130:131], v[66:67] op_sel_hi:[0,1,1] neg_lo:[1,0,0] neg_hi:[1,0,0]
  v_pk_fma_f32 v[68:69], v[42:43], v[132:133], v[68:69] op_sel_hi:[0,1,1] neg_lo:[1,0,0] neg_hi:[1,0,0]
  v_pk_fma_f32 v[70:71], v[42:43], v[134:135], v[70:71] op_sel_hi:[0,1,1] neg_lo:[1,0,0] neg_hi:[1,0,0]
  v_pk_mul_f32 v[64:65], v[64:65], v[50:51] op_sel_hi:[1,0]
  v_pk_mul_f32 v[66:67], v[66:67], v[50:51] op_sel_hi:[1,0]
  v_pk_mul_f32 v[68:69], v[68:69], v[50:51] op_sel_hi:[1,0]
  v_pk_mul_f32 v[70:71], v[70:71], v[50:51] op_sel_hi:[1,0]
  v_cvt_pk_bf16_f32 v10, v64, v65
  v_cvt_pk_bf16_f32 v11, v66, v67
  v_cvt_pk_bf16_f32 v12, v68, v69
  v_cvt_pk_bf16_f32 v13, v70, v71
  v_pk_fma_f32 v[80:81], v[44:45], v[128:129], v[80:81] op_sel_hi:[0,1,1] neg_lo:[1,0,0] neg_hi:[1,0,0]
  v_pk_fma_f32 v[82:83], v[44:45], v[130:131], v[82:83] op_sel_hi:[0,1,1] neg_lo:[1,0,0] neg_hi:[1,0,0]
  v_pk_fma_f32 v[84:85], v[44:45], v[132:133], v[84:85] op_sel_hi:[0,1,1] neg_lo:[1,0,0] neg_hi:[1,0,0]
  v_pk_fma_f32 v[86:87], v[44:45], v[134:135], v[86:87] op_sel_hi:[0,1,1] neg_lo:[1,0,0] neg_hi:[1,0,0]
  v_pk_mul_f32 v[80:81], v[80:81], v[52:53] op_sel_hi:[1,0]
  v_pk_mul_f32 v[82:83], v[82:83], v[52:53] op_sel_hi:[1,0]
  v_pk_mul_f32 v[84:85], v[84:85], v[52:53] op_sel_hi:[1,0]
  v_pk_mul_f32 v[86:87], v[86:87], v[52:53] op_sel_hi:[1,0]
  v_cvt_pk_bf16_f32 v16, v80, v81
  v_cvt_pk_bf16_f32 v17, v82, v83
  v_cvt_pk_bf16_f32 v18, v84, v85
  v_cvt_pk_bf16_f32 v19, v86, v87
  s_waitcnt vmcnt(0)
  s_barrier
  s_add_u32 s55, s55, 32
  s_cmp_lg_u32 s18, 0
  s_cbranch_scc1 GA_g
  v_mov_b32 v6, 0
  v_mov_b32 v7, 1
  s_and_b32 s21, s16, 7
  s_lshl_b32 s21, s21, 8
  s_add_u32 s21, s21, 0x8000
  s_mov_b64 exec, 1
  buffer_atomic_add v7, v6, s[8:11], s21 offen sc1
  s_mov_b64 exec, -1
GA_g:
  s_nop 0
  v_add_u32 v22, 102400, v2
  ds_read_b128 v[64:67], v22
  v_lshlrev_b32 v6, 3, v1
  v_add_u32 v6, 103424, v6
  ds_read_b64 v[68:69], v6
  v_cmp_gt_u32 vcc, 32, v1
  s_nop 1
  v_cndmask_b32 v14, 0, v14, vcc
  v_cndmask_b32 v15, 0, v15, vcc
  v_cndmask_b32 v20, 0, v20, vcc
  v_cndmask_b32 v21, 0, v21, vcc
  s_waitcnt lgkmcnt(1)
  v_mfma_f32_32x32x16_bf16 v[72:87], v[64:67], v[10:13], 0
  v_mfma_f32_32x32x16_bf16 v[88:103], v[64:67], v[16:19], 0
  s_waitcnt lgkmcnt(0)
  v_mfma_f32_32x32x8_bf16 v[72:87], v[68:69], v[14:15], v[72:87]
  v_mfma_f32_32x32x8_bf16 v[88:103], v[68:69], v[20:21], v[88:103]
  s_nop 10
  v_max3_f32 v23, v72, v73, v74
  v_max3_f32 v23, v23, v75, v76
  v_max3_f32 v23, v23, v77, v78
  v_max3_f32 v23, v23, v79, v80
  v_max3_f32 v23, v23, v81, v82
  v_max3_f32 v23, v23, v83, v84
  v_max3_f32 v23, v23, v85, v86
  v_max_f32 v23, v23, v87
  v_mov_b32 v6, v23
  s_nop 1
  v_permlane32_swap_b32 v23, v6
  v_max_f32 v23, v23, v6
  v_sub_f32 v6, 0, v23
  v_and_b32 v7, 0xffff0000, v6
  v_sub_f32 v6, v6, v7
  v_and_b32 v8, 0xffff0000, v6
  v_sub_f32 v6, v6, v8
  v_lshrrev_b32 v7, 16, v7
  v_or_b32 v7, v7, v8
  v_lshrrev_b32 v6, 16, v6
  v_cmp_gt_u32 vcc, 32, v1
  s_nop 1
  v_cndmask_b32 v14, v7, v14, vcc
  v_cndmask_b32 v15, v6, v15, vcc
  v_max3_f32 v24, v88, v89, v90
  v_max3_f32 v24, v24, v91, v92
  v_max3_f32 v24, v24, v93, v94
  v_max3_f32 v24, v24, v95, v96
  v_max3_f32 v24, v24, v97, v98
  v_max3_f32 v24, v24, v99, v100
  v_max3_f32 v24, v24, v101, v102
  v_max_f32 v24, v24, v103
  v_mov_b32 v6, v24
  s_nop 1
  v_permlane32_swap_b32 v24, v6
  v_max_f32 v24, v24, v6
  v_sub_f32 v6, 0, v24
  v_and_b32 v7, 0xffff0000, v6
  v_sub_f32 v6, v6, v7
  v_and_b32 v8, 0xffff0000, v6
  v_sub_f32 v6, v6, v8
  v_lshrrev_b32 v7, 16, v7
  v_or_b32 v7, v7, v8
  v_lshrrev_b32 v6, 16, v6
  v_cmp_gt_u32 vcc, 32, v1
  s_nop 1
  v_cndmask_b32 v20, v7, v20, vcc
  v_cndmask_b32 v21, v6, v21, vcc
  v_add_u32 v25, 86016, v2
  v_lshlrev_b32 v26, 3, v1
  v_add_u32 v26, 87040, v26
  s_lshl_b32 s21, s18, 12
  v_add_u32 v22, s21, v25
  v_add_u32 v7, s21, v26
  ds_write_b128 v22, v[10:13] offset:0
  ds_write_b64 v7, v[14:15] offset:0
  ds_write_b128 v22, v[16:19] offset:2048
  ds_write_b64 v7, v[20:21] offset:2048
  s_waitcnt lgkmcnt(0)
  s_barrier
  ds_read_b128 v[128:131], v22 offset:0
  ds_read_b64 v[160:161], v7 offset:0
  ds_read_b128 v[132:135], v22 offset:2048
  ds_read_b64 v[162:163], v7 offset:2048
  s_add_u32 s21, s18, 1
  s_and_b32 s21, s21, 3
  s_lshl_b32 s21, s21, 12
  v_add_u32 v22, s21, v25
  v_add_u32 v7, s21, v26
  ds_read_b128 v[136:139], v22 offset:0
  ds_read_b64 v[164:165], v7 offset:0
  ds_read_b128 v[140:143], v22 offset:2048
  ds_read_b64 v[166:167], v7 offset:2048
  s_add_u32 s21, s18, 2
  s_and_b32 s21, s21, 3
  s_lshl_b32 s21, s21, 12
  v_add_u32 v22, s21, v25
  v_add_u32 v7, s21, v26
  ds_read_b128 v[144:147], v22 offset:0
  ds_read_b64 v[168:169], v7 offset:0
  ds_read_b128 v[148:151], v22 offset:2048
  ds_read_b64 v[170:171], v7 offset:2048
  s_add_u32 s21, s18, 3
  s_and_b32 s21, s21, 3
  s_lshl_b32 s21, s21, 12
  v_add_u32 v22, s21, v25
  v_add_u32 v7, s21, v26
  ds_read_b128 v[152:155], v22 offset:0
  ds_read_b64 v[172:173], v7 offset:0
  ds_read_b128 v[156:159], v22 offset:2048
  ds_read_b64 v[174:175], v7 offset:2048
  s_waitcnt lgkmcnt(0)
  v_accvgpr_write_b32 a0, 0
  v_accvgpr_write_b32 a1, 0
  v_accvgpr_write_b32 a2, 0
  v_accvgpr_write_b32 a3, 0
  v_accvgpr_write_b32 a4, 0
  v_accvgpr_write_b32 a5, 0
  v_accvgpr_write_b32 a6, 0
  v_accvgpr_write_b32 a7, 0
  v_accvgpr_write_b32 a8, 0
  v_accvgpr_write_b32 a9, 0
  v_accvgpr_write_b32 a10, 0
  v_accvgpr_write_b32 a11, 0
  v_accvgpr_write_b32 a12, 0
  v_accvgpr_write_b32 a13, 0
  v_accvgpr_write_b32 a14, 0
  v_accvgpr_write_b32 a15, 0
  v_accvgpr_write_b32 a16, 0
  v_accvgpr_write_b32 a17, 0
  v_accvgpr_write_b32 a18, 0
  v_accvgpr_write_b32 a19, 0
  v_accvgpr_write_b32 a20, 0
  v_accvgpr_write_b32 a21, 0
  v_accvgpr_write_b32 a22, 0
  v_accvgpr_write_b32 a23, 0
  v_accvgpr_write_b32 a24, 0
  v_accvgpr_write_b32 a25, 0
  v_accvgpr_write_b32 a26, 0
  v_accvgpr_write_b32 a27, 0
  v_accvgpr_write_b32 a28, 0
  v_accvgpr_write_b32 a29, 0
  v_accvgpr_write_b32 a30, 0
  v_accvgpr_write_b32 a31, 0
  s_add_u32 s47, s41, 0
  s_add_u32 s58, s4, s47
  s_addc_u32 s59, s5, 0
  global_load_dwordx4 a[128:131], v2, s[58:59] offset:0
  s_mov_b32 s35, 0x8000
  v_and_b32 v253, 7, v1
  v_lshlrev_b32 v253, 8, v253
  s_cmp_lg_u32 s18, 0
  s_cbranch_scc1 PL0_gw
  buffer_load_dword v254, v253, s[8:11], s35 offen sc1
PL0_gw:
  global_load_dwordx4 a[132:135], v2, s[58:59] offset:1024
  global_load_dwordx4 a[136:139], v2, s[58:59] offset:2048
  global_load_dwordx4 a[140:143], v2, s[58:59] offset:3072
  s_cmp_lg_u32 s18, 0
  s_cbranch_scc1 POLLE_gw
  s_waitcnt vmcnt(3)
  s_mov_b32 s23, 0
  v_cmp_le_u32 vcc, s55, v254
  s_nop 3
  s_cmp_eq_u64 vcc, exec
  s_cbranch_scc1 POLLD_gw
POLL_gw:
  buffer_load_dword v254, v253, s[8:11], s35 offen sc1
  s_waitcnt vmcnt(0)
  s_add_u32 s23, s23, 1
  v_cmp_le_u32 vcc, s55, v254
  s_nop 3
  s_cmp_eq_u64 vcc, exec
  s_cbranch_scc1 POLLD_gw
  s_cmp_lt_u32 s23, 400000
  s_cbranch_scc1 POLL_gw
POLLD_gw:
POLLE_gw:
  s_barrier
  s_add_u32 s26, s20, 0x902000
  s_mul_i32 s21, s18, 49152
  s_add_u32 s26, s26, s21
  v_lshlrev_b32 v22, 3, v1
  v_add_u32 v22, 1024, v22
  v_and_b32 v6, 31, v1
  v_lshrrev_b32 v8, 5, v1
  v_mul_u32_u24 v8, 384, v8
  v_lshl_add_u32 v23, v6, 4, v8
  v_add_u32 v23, 1536, v23
  v_mov_b32 v7, 0x40000000
  v_cmp_ge_u32 vcc, 20, v6
  s_nop 1
  v_cndmask_b32 v23, v7, v23, vcc
  s_mov_b32 s29, 0
ATT_RUN_a:
  s_nop 1
  s_mul_i32 s31, s17, 102400
  s_mul_i32 s21, s18, 3072
  s_add_u32 s31, s31, s21
  s_add_u32 s31, s31, 0x1d0000
  s_add_u32 s32, s21, 0
  s_mov_b32 s27, s26
  buffer_load_dwordx4 v[64:67], v2, s[8:11], s27 offen sc1
  buffer_load_dwordx2 v[68:69], v22, s[8:11], s27 offen sc1
  buffer_load_dwordx4 v[72:75], v23, s[8:11], s27 offen sc1
  buffer_load_dwordx4 v[76:79], v23, s[8:11], s27 offen offset:768 sc1
  s_add_u32 s27, s27, 3072
  buffer_load_dwordx4 v[80:83], v2, s[8:11], s27 offen sc1
  buffer_load_dwordx2 v[84:85], v22, s[8:11], s27 offen sc1
  v_mov_b32 v184, 0
  v_mov_b32 v185, 0
  v_mov_b32 v186, 0
  v_mov_b32 v187, 0
  v_mov_b32 v188, 0
  v_mov_b32 v189, 0
  v_mov_b32 v190, 0
  v_mov_b32 v191, 0
  v_mov_b32 v88, 0
  v_mov_b32 v89, 0
  v_mov_b32 v90, 0
  v_mov_b32 v91, 0
  v_mov_b32 v92, 0
  v_mov_b32 v93, 0
  v_mov_b32 v94, 0
  v_mov_b32 v95, 0
  v_mov_b32 v124, 0
  v_mov_b32 v125, 0
  v_mov_b32 v126, 0
  v_mov_b32 v127, 0
  s_waitcnt vmcnt(5)
  v_mfma_f32_32x32x16_bf16 v[96:111], v[64:67], v[136:139], 0
  s_nop 9
  s_waitcnt vmcnt(4)
  v_mfma_f32_32x32x8_bf16 v[96:111], v[68:69], v[164:165], v[96:111]
  s_nop 11
  s_mov_b32 s28, 7
  s_add_u32 s21, s18, 1
  s_and_b32 s21, s21, 3
  s_mul_i32 s21, s21, 18432
  s_add_u32 s21, s21, 86016
  v_add_u32 v24, s21, v2
  s_add_u32 s21, s18, 2
  s_and_b32 s21, s21, 3
  s_mul_i32 s21, s21, 18432
  s_add_u32 s21, s21, 92160
  v_add_u32 v25, s21, v2
  s_add_u32 s21, s18, 3
  s_and_b32 s21, s21, 3
  s_mul_i32 s21, s21, 18432
  s_add_u32 s21, s21, 98304
  v_add_u32 v26, s21, v2
  s_mul_i32 s21, s18, 18432
  s_add_u32 s21, s21, 86016
  v_add_u32 v31, s21, v2
  s_mul_i32 s21, s17, 10240
  s_add_u32 s45, s43, s21
  s_add_u32 s45, s45, 0x1832000
  s_mul_i32 s21, s18, 5
  v_lshrrev_b32 v6, 5, v1
  v_add_u32 v6, s21, v6
  v_lshrrev_b32 v7, 1, v6
  v_lshlrev_b32 v216, 10, v7
  v_and_b32 v7, 1, v6
  v_lshl_add_u32 v216, v7, 3, v216
  v_and_b32 v7, 31, v1
  v_lshl_add_u32 v216, v7, 4, v216
  v_cmp_gt_u32 vcc, 32, v1
  v_mov_b32 v7, 0x40000000
  s_nop 0
  v_cndmask_b32 v217, v7, v216, vcc
  s_lshl_b32 s22, s18, 2
  s_add_u32 s22, s22, 162304
  v_mov_b32 v218, s22
  s_mul_i32 s21, s18, 18432
  s_add_u32 s21, s21, 86016
  v_lshrrev_b32 v6, 5, v1
  v_lshlrev_b32 v6, 9, v6
  v_and_b32 v7, 31, v1
  v_lshl_add_u32 v6, v7, 3, v6
  v_add_u32 v219, s21, v6
  s_add_u32 s21, s18, 0
  s_min_u32 s21, s21, 9
  s_lshl_b32 s21, s21, 1
  s_add_u32 s21, s21, 0
  s_mul_i32 s22, s21, 52
  s_lshr_b32 s22, s22, 8
  s_mul_i32 s23, s22, 5
  s_sub_u32 s21, s21, s23
  s_mul_i32 s22, s22, 18432
  s_lshl_b32 s21, s21, 9
  s_add_u32 s21, s21, s22
  s_add_u32 s21, s21, 86016
  v_lshlrev_b32 v6, 3, v1
  v_add_u32 v221, s21, v6
  s_add_u32 s21, s18, 0
  s_min_u32 s21, s21, 9
  s_lshl_b32 s21, s21, 1
  s_add_u32 s21, s21, 1
  s_mul_i32 s22, s21, 52
  s_lshr_b32 s22, s22, 8
  s_mul_i32 s23, s22, 5
  s_sub_u32 s21, s21, s23
  s_mul_i32 s22, s22, 18432
  s_lshl_b32 s21, s21, 9
  s_add_u32 s21, s21, s22
  s_add_u32 s21, s21, 86016
  v_lshlrev_b32 v6, 3, v1
  v_add_u32 v222, s21, v6
  s_add_u32 s21, s18, 4
  s_min_u32 s21, s21, 9
  s_lshl_b32 s21, s21, 1
  s_add_u32 s21, s21, 0
  s_mul_i32 s22, s21, 52
  s_lshr_b32 s22, s22, 8
  s_mul_i32 s23, s22, 5
  s_sub_u32 s21, s21, s23
  s_mul_i32 s22, s22, 18432
  s_lshl_b32 s21, s21, 9
  s_add_u32 s21, s21, s22
  s_add_u32 s21, s21, 86016
  v_lshlrev_b32 v6, 3, v1
  v_add_u32 v223, s21, v6
  s_add_u32 s21, s18, 4
  s_min_u32 s21, s21, 9
  s_lshl_b32 s21, s21, 1
  s_add_u32 s21, s21, 1
  s_mul_i32 s22, s21, 52
  s_lshr_b32 s22, s22, 8
  s_mul_i32 s23, s22, 5
  s_sub_u32 s21, s21, s23
  s_mul_i32 s22, s22, 18432
  s_lshl_b32 s21, s21, 9
  s_add_u32 s21, s21, s22
  s_add_u32 s21, s21, 86016
  v_lshlrev_b32 v6, 3, v1
  v_add_u32 v224, s21, v6
  s_add_u32 s21, s18, 8
  s_min_u32 s21, s21, 9
  s_lshl_b32 s21, s21, 1
  s_add_u32 s21, s21, 0
  s_mul_i32 s22, s21, 52
  s_lshr_b32 s22, s22, 8
  s_mul_i32 s23, s22, 5
  s_sub_u32 s21, s21, s23
  s_mul_i32 s22, s22, 18432
  s_lshl_b32 s21, s21, 9
  s_add_u32 s21, s21, s22
  s_add_u32 s21, s21, 86016
  v_lshlrev_b32 v6, 3, v1
  v_add_u32 v225, s21, v6
  s_add_u32 s21, s18, 8
  s_min_u32 s21, s21, 9
  s_lshl_b32 s21, s21, 1
  s_add_u32 s21, s21, 1
  s_mul_i32 s22, s21, 52
  s_lshr_b32 s22, s22, 8
  s_mul_i32 s23, s22, 5
  s_sub_u32 s21, s21, s23
  s_mul_i32 s22, s22, 18432
  s_lshl_b32 s21, s21, 9
  s_add_u32 s21, s21, s22
  s_add_u32 s21, s21, 86016
  v_lshlrev_b32 v6, 3, v1
  v_add_u32 v226, s21, v6
  s_cmp_lt_u32 s18, 2
  s_cselect_b32 s21, 0, 0x40000000
  v_add_u32 v220, s21, v2
  s_lshl_b32 s21, s18, 10
  s_add_u32 s45, s45, s21
.p2align 6
ATT_LOOP_a:
  v_cvt_pk_bf16_f32 v190, v124, v125
  v_exp_f32 v96, v96
  v_cvt_pk_bf16_f32 v191, v126, v127
  v_exp_f32 v97, v97
  v_mfma_f32_32x32x16_bf16 v[112:127], v[64:67], v[140:143], 0
  v_exp_f32 v98, v98
  v_exp_f32 v99, v99
  v_exp_f32 v100, v100
  v_exp_f32 v101, v101
  v_cvt_pk_bf16_f32 v176, v96, v97
  v_cvt_pk_bf16_f32 v177, v98, v99
  v_mfma_f32_32x32x16_bf16 a[16:31], v[88:91], v[184:187], a[16:31]
  v_exp_f32 v102, v102
  v_exp_f32 v103, v103
  v_exp_f32 v104, v104
  v_exp_f32 v105, v105
  v_mfma_f32_32x32x8_bf16 v[112:127], v[68:69], v[166:167], v[112:127]
  v_cvt_pk_bf16_f32 v178, v100, v101
  v_exp_f32 v106, v106
  v_exp_f32 v107, v107
  v_cvt_pk_bf16_f32 v179, v102, v103
  v_exp_f32 v108, v108
  v_exp_f32 v109, v109
  v_cvt_pk_bf16_f32 v180, v104, v105
  v_mfma_f32_32x32x16_bf16 a[16:31], v[92:95], v[188:191], a[16:31]
  v_exp_f32 v110, v110
  v_exp_f32 v111, v111
  v_cvt_pk_bf16_f32 v181, v106, v107
  v_cvt_pk_bf16_f32 v182, v108, v109
  v_exp_f32 v112, v112
  v_cvt_pk_bf16_f32 v183, v110, v111
  v_exp_f32 v113, v113
  v_mfma_f32_32x32x16_bf16 v[96:111], v[64:67], v[144:147], 0
  v_exp_f32 v114, v114
  v_exp_f32 v115, v115
  v_exp_f32 v116, v116
  v_exp_f32 v117, v117
  v_cvt_pk_bf16_f32 v184, v112, v113
  v_cvt_pk_bf16_f32 v185, v114, v115
  s_waitcnt vmcnt(3)
  v_mfma_f32_32x32x16_bf16 a[32:47], v[72:75], v[176:179], a[32:47]
  buffer_load_dwordx4 v[88:91], v23, s[8:11], s27 offen sc1
  buffer_load_dwordx4 v[92:95], v23, s[8:11], s27 offen offset:768 sc1
  v_exp_f32 v118, v118
  v_exp_f32 v119, v119
  v_exp_f32 v120, v120
  v_exp_f32 v121, v121
  v_mfma_f32_32x32x8_bf16 v[96:111], v[68:69], v[168:169], v[96:111]
  v_cvt_pk_bf16_f32 v186, v116, v117
  v_exp_f32 v122, v122
  v_exp_f32 v123, v123
  v_cvt_pk_bf16_f32 v187, v118, v119
  v_exp_f32 v124, v124
  v_exp_f32 v125, v125
  v_cvt_pk_bf16_f32 v188, v120, v121
  s_waitcnt vmcnt(4)
  v_mfma_f32_32x32x16_bf16 a[32:47], v[76:79], v[180:183], a[32:47]
  v_exp_f32 v126, v126
  v_exp_f32 v127, v127
  v_cvt_pk_bf16_f32 v189, v122, v123
  s_add_u32 s27, s27, 3072
  v_cvt_pk_bf16_f32 v190, v124, v125
  v_exp_f32 v96, v96
  v_cvt_pk_bf16_f32 v191, v126, v127
  v_exp_f32 v97, v97
  v_mfma_f32_32x32x16_bf16 v[112:127], v[64:67], v[148:151], 0
  v_exp_f32 v98, v98
  v_exp_f32 v99, v99
  v_exp_f32 v100, v100
  v_exp_f32 v101, v101
  v_cvt_pk_bf16_f32 v176, v96, v97
  v_cvt_pk_bf16_f32 v177, v98, v99
  v_mfma_f32_32x32x16_bf16 a[48:63], v[72:75], v[184:187], a[48:63]
  v_exp_f32 v102, v102
  v_exp_f32 v103, v103
  v_exp_f32 v104, v104
  v_exp_f32 v105, v105
  v_mfma_f32_32x32x8_bf16 v[112:127], v[68:69], v[170:171], v[112:127]
  v_cvt_pk_bf16_f32 v178, v100, v101
  v_exp_f32 v106, v106
  v_exp_f32 v107, v107
  v_cvt_pk_bf16_f32 v179, v102, v103
  v_exp_f32 v108, v108
  v_exp_f32 v109, v109
  v_cvt_pk_bf16_f32 v180, v104, v105
  v_mfma_f32_32x32x16_bf16 a[48:63], v[76:79], v[188:191], a[48:63]
  v_exp_f32 v110, v110
  v_exp_f32 v111, v111
  v_cvt_pk_bf16_f32 v181, v106, v107
  v_cvt_pk_bf16_f32 v182, v108, v109
  v_exp_f32 v112, v112
  v_cvt_pk_bf16_f32 v183, v110, v111
  v_exp_f32 v113, v113
  v_mfma_f32_32x32x16_bf16 v[96:111], v[64:67], v[152:155], 0
  v_exp_f32 v114, v114
  v_exp_f32 v115, v115
  v_exp_f32 v116, v116
  v_exp_f32 v117, v117
  v_cvt_pk_bf16_f32 v184, v112, v113
  v_cvt_pk_bf16_f32 v185, v114, v115
  v_mfma_f32_32x32x16_bf16 a[64:79], v[72:75], v[176:179], a[64:79]
  s_mov_b32 m0, s32
  s_nop 0
  buffer_load_dwordx4 v2, s[8:11], s31 offen offset:0  lds
  buffer_load_dwordx4 v2, s[8:11], s31 offen offset:1024  lds
  buffer_load_dwordx4 v2, s[8:11], s31 offen offset:2048  lds
  s_add_u32 s31, s31, 12288
  s_add_u32 s32, s32, 12288
  v_exp_f32 v118, v118
  v_exp_f32 v119, v119
  v_exp_f32 v120, v120
  v_exp_f32 v121, v121
  v_mfma_f32_32x32x8_bf16 v[96:111], v[68:69], v[172:173], v[96:111]
  v_cvt_pk_bf16_f32 v186, v116, v117
  v_exp_f32 v122, v122
  v_exp_f32 v123, v123
  v_cvt_pk_bf16_f32 v187, v118, v119
  v_exp_f32 v124, v124
  v_exp_f32 v125, v125
  v_cvt_pk_bf16_f32 v188, v120, v121
  v_mfma_f32_32x32x16_bf16 a[64:79], v[76:79], v[180:183], a[64:79]
  v_exp_f32 v126, v126
  v_exp_f32 v127, v127
  v_cvt_pk_bf16_f32 v189, v122, v123
  v_cvt_pk_bf16_f32 v190, v124, v125
  v_exp_f32 v96, v96
  v_cvt_pk_bf16_f32 v191, v126, v127
  v_exp_f32 v97, v97
  v_mfma_f32_32x32x16_bf16 v[112:127], v[64:67], v[156:159], 0
  v_exp_f32 v98, v98
  v_exp_f32 v99, v99
  v_exp_f32 v100, v100
  v_exp_f32 v101, v101
  v_cvt_pk_bf16_f32 v176, v96, v97
  v_cvt_pk_bf16_f32 v177, v98, v99
  v_mfma_f32_32x32x16_bf16 a[80:95], v[72:75], v[184:187], a[80:95]
  v_exp_f32 v102, v102
  v_exp_f32 v103, v103
  v_exp_f32 v104, v104
  v_exp_f32 v105, v105
  v_mfma_f32_32x32x8_bf16 v[112:127], v[68:69], v[174:175], v[112:127]
  v_cvt_pk_bf16_f32 v178, v100, v101
  v_exp_f32 v106, v106
  v_exp_f32 v107, v107
  v_cvt_pk_bf16_f32 v179, v102, v103
  v_exp_f32 v108, v108
  v_exp_f32 v109, v109
  v_cvt_pk_bf16_f32 v180, v104, v105
  v_mfma_f32_32x32x16_bf16 a[80:95], v[76:79], v[188:191], a[80:95]
  v_exp_f32 v110, v110
  v_exp_f32 v111, v111
  v_cvt_pk_bf16_f32 v181, v106, v107
  v_cvt_pk_bf16_f32 v182, v108, v109
  v_exp_f32 v112, v112
  v_cvt_pk_bf16_f32 v183, v110, v111
  v_exp_f32 v113, v113
  v_mfma_f32_32x32x16_bf16 v[96:111], v[64:67], v[128:131], 0
  v_exp_f32 v114, v114
  v_exp_f32 v115, v115
  v_exp_f32 v116, v116
  v_exp_f32 v117, v117
  v_cvt_pk_bf16_f32 v184, v112, v113
  v_cvt_pk_bf16_f32 v185, v114, v115
  v_mfma_f32_32x32x16_bf16 a[96:111], v[72:75], v[176:179], a[96:111]
  v_exp_f32 v118, v118
  v_exp_f32 v119, v119
  v_exp_f32 v120, v120
  v_exp_f32 v121, v121
  v_mfma_f32_32x32x8_bf16 v[96:111], v[68:69], v[160:161], v[96:111]
  v_cvt_pk_bf16_f32 v186, v116, v117
  v_exp_f32 v122, v122
  v_exp_f32 v123, v123
  v_cvt_pk_bf16_f32 v187, v118, v119
  v_exp_f32 v124, v124
  v_exp_f32 v125, v125
  v_cvt_pk_bf16_f32 v188, v120, v121
  v_mfma_f32_32x32x16_bf16 a[96:111], v[76:79], v[180:183], a[96:111]
  v_exp_f32 v126, v126
  v_exp_f32 v127, v127
  v_cvt_pk_bf16_f32 v189, v122, v123
  v_cvt_pk_bf16_f32 v190, v124, v125
  v_exp_f32 v96, v96
  v_cvt_pk_bf16_f32 v191, v126, v127
  v_exp_f32 v97, v97
  v_mfma_f32_32x32x16_bf16 v[112:127], v[64:67], v[132:135], 0
  v_exp_f32 v98, v98
  v_exp_f32 v99, v99
  v_exp_f32 v100, v100
  v_exp_f32 v101, v101
  v_cvt_pk_bf16_f32 v176, v96, v97
  v_cvt_pk_bf16_f32 v177, v98, v99
  v_mfma_f32_32x32x16_bf16 a[112:127], v[72:75], v[184:187], a[112:127]
  v_exp_f32 v102, v102
  v_exp_f32 v103, v103
  v_exp_f32 v104, v104
  v_exp_f32 v105, v105
  v_mfma_f32_32x32x8_bf16 v[112:127], v[68:69], v[162:163], v[112:127]
  v_cvt_pk_bf16_f32 v178, v100, v101
  v_exp_f32 v106, v106
  v_exp_f32 v107, v107
  v_cvt_pk_bf16_f32 v179, v102, v103
  v_exp_f32 v108, v108
  v_exp_f32 v109, v109
  v_cvt_pk_bf16_f32 v180, v104, v105
  v_mfma_f32_32x32x16_bf16 a[112:127], v[76:79], v[188:191], a[112:127]
  v_exp_f32 v110, v110
  v_exp_f32 v111, v111
  v_cvt_pk_bf16_f32 v181, v106, v107
  v_cvt_pk_bf16_f32 v182, v108, v109
  v_exp_f32 v112, v112
  v_cvt_pk_bf16_f32 v183, v110, v111
  v_exp_f32 v113, v113
  s_waitcnt vmcnt(6)
  v_mfma_f32_32x32x16_bf16 v[96:111], v[80:83], v[136:139], 0
  v_exp_f32 v114, v114
  v_exp_f32 v115, v115
  v_exp_f32 v116, v116
  v_exp_f32 v117, v117
  v_cvt_pk_bf16_f32 v184, v112, v113
  v_cvt_pk_bf16_f32 v185, v114, v115
  v_mfma_f32_32x32x16_bf16 a[0:15], v[72:75], v[176:179], a[0:15]
  v_exp_f32 v118, v118
  v_exp_f32 v119, v119
  v_exp_f32 v120, v120
  v_exp_f32 v121, v121
  s_waitcnt vmcnt(5)
  v_mfma_f32_32x32x8_bf16 v[96:111], v[84:85], v[164:165], v[96:111]
  v_cvt_pk_bf16_f32 v186, v116, v117
  v_exp_f32 v122, v122
  v_exp_f32 v123, v123
  v_cvt_pk_bf16_f32 v187, v118, v119
  v_exp_f32 v124, v124
  v_exp_f32 v125, v125
  v_cvt_pk_bf16_f32 v188, v120, v121
  v_mfma_f32_32x32x16_bf16 a[0:15], v[76:79], v[180:183], a[0:15]
  v_exp_f32 v126, v126
  v_exp_f32 v127, v127
  v_cvt_pk_bf16_f32 v189, v122, v123
  buffer_load_dwordx4 v[64:67], v2, s[8:11], s27 offen sc1
  buffer_load_dwordx2 v[68:69], v22, s[8:11], s27 offen sc1
  v_cvt_pk_bf16_f32 v190, v124, v125
  v_exp_f32 v96, v96
  v_cvt_pk_bf16_f32 v191, v126, v127
  v_exp_f32 v97, v97
  v_mfma_f32_32x32x16_bf16 v[112:127], v[80:83], v[140:143], 0
  v_exp_f32 v98, v98
  v_exp_f32 v99, v99
  v_exp_f32 v100, v100
  v_exp_f32 v101, v101
  v_cvt_pk_bf16_f32 v176, v96, v97
  v_cvt_pk_bf16_f32 v177, v98, v99
  v_mfma_f32_32x32x16_bf16 a[16:31], v[72:75], v[184:187], a[16:31]
  v_exp_f32 v102, v102
  v_exp_f32 v103, v103
  v_exp_f32 v104, v104
  v_exp_f32 v105, v105
  v_mfma_f32_32x32x8_bf16 v[112:127], v[84:85], v[166:167], v[112:127]
  v_cvt_pk_bf16_f32 v178, v100, v101
  v_exp_f32 v106, v106
  v_exp_f32 v107, v107
  v_cvt_pk_bf16_f32 v179, v102, v103
  v_exp_f32 v108, v108
  v_exp_f32 v109, v109
  v_cvt_pk_bf16_f32 v180, v104, v105
  v_mfma_f32_32x32x16_bf16 a[16:31], v[76:79], v[188:191], a[16:31]
  v_exp_f32 v110, v110
  v_exp_f32 v111, v111
  v_cvt_pk_bf16_f32 v181, v106, v107
  v_cvt_pk_bf16_f32 v182, v108, v109
  v_exp_f32 v112, v112
  v_cvt_pk_bf16_f32 v183, v110, v111
  v_exp_f32 v113, v113
  v_mfma_f32_32x32x16_bf16 v[96:111], v[80:83], v[144:147], 0
  v_exp_f32 v114, v114
  v_exp_f32 v115, v115
  v_exp_f32 v116, v116
  v_exp_f32 v117, v117
  v_cvt_pk_bf16_f32 v184, v112, v113
  v_cvt_pk_bf16_f32 v185, v114, v115
  s_waitcnt vmcnt(6)
  v_mfma_f32_32x32x16_bf16 a[32:47], v[88:91], v[176:179], a[32:47]
  buffer_load_dwordx4 v[72:75], v23, s[8:11], s27 offen sc1
  buffer_load_dwordx4 v[76:79], v23, s[8:11], s27 offen offset:768 sc1
  v_exp_f32 v118, v118
  v_exp_f32 v119, v119
  v_exp_f32 v120, v120
  v_exp_f32 v121, v121
  v_mfma_f32_32x32x8_bf16 v[96:111], v[84:85], v[168:169], v[96:111]
  v_cvt_pk_bf16_f32 v186, v116, v117
  v_exp_f32 v122, v122
  v_exp_f32 v123, v123
  v_cvt_pk_bf16_f32 v187, v118, v119
  v_exp_f32 v124, v124
  v_exp_f32 v125, v125
  v_cvt_pk_bf16_f32 v188, v120, v121
  s_waitcnt vmcnt(7)
  v_mfma_f32_32x32x16_bf16 a[32:47], v[92:95], v[180:183], a[32:47]
  v_exp_f32 v126, v126
  v_exp_f32 v127, v127
  v_cvt_pk_bf16_f32 v189, v122, v123
  s_add_u32 s27, s27, 3072
  v_cvt_pk_bf16_f32 v190, v124, v125
  v_exp_f32 v96, v96
  v_cvt_pk_bf16_f32 v191, v126, v127
  v_exp_f32 v97, v97
  v_mfma_f32_32x32x16_bf16 v[112:127], v[80:83], v[148:151], 0
  v_exp_f32 v98, v98
  v_exp_f32 v99, v99
  v_exp_f32 v100, v100
  v_exp_f32 v101, v101
  v_cvt_pk_bf16_f32 v176, v96, v97
  v_cvt_pk_bf16_f32 v177, v98, v99
  v_mfma_f32_32x32x16_bf16 a[48:63], v[88:91], v[184:187], a[48:63]
  v_exp_f32 v102, v102
  v_exp_f32 v103, v103
  v_exp_f32 v104, v104
  v_exp_f32 v105, v105
  v_mfma_f32_32x32x8_bf16 v[112:127], v[84:85], v[170:171], v[112:127]
  v_cvt_pk_bf16_f32 v178, v100, v101
  v_exp_f32 v106, v106
  v_exp_f32 v107, v107
  v_cvt_pk_bf16_f32 v179, v102, v103
  v_exp_f32 v108, v108
  v_exp_f32 v109, v109
  v_cvt_pk_bf16_f32 v180, v104, v105
  v_mfma_f32_32x32x16_bf16 a[48:63], v[92:95], v[188:191], a[48:63]
  v_exp_f32 v110, v110
  v_exp_f32 v111, v111
  v_cvt_pk_bf16_f32 v181, v106, v107
  v_cvt_pk_bf16_f32 v182, v108, v109
  v_exp_f32 v112, v112
  v_cvt_pk_bf16_f32 v183, v110, v111
  v_exp_f32 v113, v113
  v_mfma_f32_32x32x16_bf16 v[96:111], v[80:83], v[152:155], 0
  v_exp_f32 v114, v114
  v_exp_f32 v115, v115
  v_exp_f32 v116, v116
  v_exp_f32 v117, v117
  v_cvt_pk_bf16_f32 v184, v112, v113
  v_cvt_pk_bf16_f32 v185, v114, v115
  v_mfma_f32_32x32x16_bf16 a[64:79], v[88:91], v[176:179], a[64:79]
  v_exp_f32 v118, v118
  v_exp_f32 v119, v119
  v_exp_f32 v120, v120
  v_exp_f32 v121, v121
  v_mfma_f32_32x32x8_bf16 v[96:111], v[84:85], v[172:173], v[96:111]
  v_cvt_pk_bf16_f32 v186, v116, v117
  v_exp_f32 v122, v122
  v_exp_f32 v123, v123
  v_cvt_pk_bf16_f32 v187, v118, v119
  v_exp_f32 v124, v124
  v_exp_f32 v125, v125
  v_cvt_pk_bf16_f32 v188, v120, v121
  v_mfma_f32_32x32x16_bf16 a[64:79], v[92:95], v[180:183], a[64:79]
  v_exp_f32 v126, v126
  v_exp_f32 v127, v127
  v_cvt_pk_bf16_f32 v189, v122, v123
  v_cvt_pk_bf16_f32 v190, v124, v125
  v_exp_f32 v96, v96
  v_cvt_pk_bf16_f32 v191, v126, v127
  v_exp_f32 v97, v97
  v_mfma_f32_32x32x16_bf16 v[112:127], v[80:83], v[156:159], 0
  v_exp_f32 v98, v98
  v_exp_f32 v99, v99
  v_exp_f32 v100, v100
  v_exp_f32 v101, v101
  v_cvt_pk_bf16_f32 v176, v96, v97
  v_cvt_pk_bf16_f32 v177, v98, v99
  v_mfma_f32_32x32x16_bf16 a[80:95], v[88:91], v[184:187], a[80:95]
  v_exp_f32 v102, v102
  v_exp_f32 v103, v103
  v_exp_f32 v104, v104
  v_exp_f32 v105, v105
  v_mfma_f32_32x32x8_bf16 v[112:127], v[84:85], v[174:175], v[112:127]
  v_cvt_pk_bf16_f32 v178, v100, v101
  v_exp_f32 v106, v106
  v_exp_f32 v107, v107
  v_cvt_pk_bf16_f32 v179, v102, v103
  v_exp_f32 v108, v108
  v_exp_f32 v109, v109
  v_cvt_pk_bf16_f32 v180, v104, v105
  v_mfma_f32_32x32x16_bf16 a[80:95], v[92:95], v[188:191], a[80:95]
  v_exp_f32 v110, v110
  v_exp_f32 v111, v111
  v_cvt_pk_bf16_f32 v181, v106, v107
  v_cvt_pk_bf16_f32 v182, v108, v109
  v_exp_f32 v112, v112
  v_cvt_pk_bf16_f32 v183, v110, v111
  v_exp_f32 v113, v113
  v_mfma_f32_32x32x16_bf16 v[96:111], v[80:83], v[128:131], 0
  v_exp_f32 v114, v114
  v_exp_f32 v115, v115
  v_exp_f32 v116, v116
  v_exp_f32 v117, v117
  v_cvt_pk_bf16_f32 v184, v112, v113
  v_cvt_pk_bf16_f32 v185, v114, v115
  v_mfma_f32_32x32x16_bf16 a[96:111], v[88:91], v[176:179], a[96:111]
  v_exp_f32 v118, v118
  v_exp_f32 v119, v119
  v_exp_f32 v120, v120
  v_exp_f32 v121, v121
  v_mfma_f32_32x32x8_bf16 v[96:111], v[84:85], v[160:161], v[96:111]
  v_cvt_pk_bf16_f32 v186, v116, v117
  v_exp_f32 v122, v122
  v_exp_f32 v123, v123
  v_cvt_pk_bf16_f32 v187, v118, v119
  v_exp_f32 v124, v124
  v_exp_f32 v125, v125
  v_cvt_pk_bf16_f32 v188, v120, v121
  v_mfma_f32_32x32x16_bf16 a[96:111], v[92:95], v[180:183], a[96:111]
  v_exp_f32 v126, v126
  v_exp_f32 v127, v127
  v_cvt_pk_bf16_f32 v189, v122, v123
  v_cvt_pk_bf16_f32 v190, v124, v125
  v_exp_f32 v96, v96
  v_cvt_pk_bf16_f32 v191, v126, v127
  v_exp_f32 v97, v97
  v_mfma_f32_32x32x16_bf16 v[112:127], v[80:83], v[132:135], 0
  v_exp_f32 v98, v98
  v_exp_f32 v99, v99
  v_exp_f32 v100, v100
  v_exp_f32 v101, v101
  v_cvt_pk_bf16_f32 v176, v96, v97
  v_cvt_pk_bf16_f32 v177, v98, v99
  v_mfma_f32_32x32x16_bf16 a[112:127], v[88:91], v[184:187], a[112:127]
  v_exp_f32 v102, v102
  v_exp_f32 v103, v103
  v_exp_f32 v104, v104
  v_exp_f32 v105, v105
  v_mfma_f32_32x32x8_bf16 v[112:127], v[84:85], v[162:163], v[112:127]
  v_cvt_pk_bf16_f32 v178, v100, v101
  v_exp_f32 v106, v106
  v_exp_f32 v107, v107
  v_cvt_pk_bf16_f32 v179, v102, v103
  v_exp_f32 v108, v108
  v_exp_f32 v109, v109
  v_cvt_pk_bf16_f32 v180, v104, v105
  v_mfma_f32_32x32x16_bf16 a[112:127], v[92:95], v[188:191], a[112:127]
  v_exp_f32 v110, v110
  v_exp_f32 v111, v111
  v_cvt_pk_bf16_f32 v181, v106, v107
  v_cvt_pk_bf16_f32 v182, v108, v109
  v_exp_f32 v112, v112
  v_cvt_pk_bf16_f32 v183, v110, v111
  v_exp_f32 v113, v113
  s_waitcnt vmcnt(3)
  v_mfma_f32_32x32x16_bf16 v[96:111], v[64:67], v[136:139], 0
  v_exp_f32 v114, v114
  v_exp_f32 v115, v115
  v_exp_f32 v116, v116
  v_exp_f32 v117, v117
  v_cvt_pk_bf16_f32 v184, v112, v113
  v_cvt_pk_bf16_f32 v185, v114, v115
  v_mfma_f32_32x32x16_bf16 a[0:15], v[88:91], v[176:179], a[0:15]
  v_exp_f32 v118, v118
  v_exp_f32 v119, v119
  v_exp_f32 v120, v120
  v_exp_f32 v121, v121
  s_waitcnt vmcnt(2)
  v_mfma_f32_32x32x8_bf16 v[96:111], v[68:69], v[164:165], v[96:111]
  v_cvt_pk_bf16_f32 v186, v116, v117
  v_exp_f32 v122, v122
  v_exp_f32 v123, v123
  v_cvt_pk_bf16_f32 v187, v118, v119
  v_exp_f32 v124, v124
  v_exp_f32 v125, v125
  v_cvt_pk_bf16_f32 v188, v120, v121
  v_mfma_f32_32x32x16_bf16 a[0:15], v[92:95], v[180:183], a[0:15]
  v_exp_f32 v126, v126
  v_exp_f32 v127, v127
  v_cvt_pk_bf16_f32 v189, v122, v123
  buffer_load_dwordx4 v[80:83], v2, s[8:11], s27 offen sc1
  buffer_load_dwordx2 v[84:85], v22, s[8:11], s27 offen sc1
  s_sub_u32 s28, s28, 1
  s_cmp_lg_u32 s28, 0
  s_cbranch_scc1 ATT_LOOP_a
  v_cvt_pk_bf16_f32 v190, v124, v125
  v_exp_f32 v96, v96
  v_cvt_pk_bf16_f32 v191, v126, v127
  v_exp_f32 v97, v97
  v_mfma_f32_32x32x16_bf16 v[112:127], v[64:67], v[140:143], 0
  v_exp_f32 v98, v98
  v_exp_f32 v99, v99
  v_exp_f32 v100, v100
  v_exp_f32 v101, v101
  v_cvt_pk_bf16_f32 v176, v96, v97
  v_cvt_pk_bf16_f32 v177, v98, v99
  v_mfma_f32_32x32x16_bf16 a[16:31], v[88:91], v[184:187], a[16:31]
  v_exp_f32 v102, v102
  v_exp_f32 v103, v103
  v_exp_f32 v104, v104
  v_exp_f32 v105, v105
  v_mfma_f32_32x32x8_bf16 v[112:127], v[68:69], v[166:167], v[112:127]
  v_cvt_pk_bf16_f32 v178, v100, v101
  v_exp_f32 v106, v106
  v_exp_f32 v107, v107
  v_cvt_pk_bf16_f32 v179, v102, v103
  v_exp_f32 v108, v108
  v_exp_f32 v109, v109
  v_cvt_pk_bf16_f32 v180, v104, v105
  v_mfma_f32_32x32x16_bf16 a[16:31], v[92:95], v[188:191], a[16:31]
  v_exp_f32 v110, v110
  v_exp_f32 v111, v111
  v_cvt_pk_bf16_f32 v181, v106, v107
  s_add_u32 s47, s41, 4096
  s_add_u32 s58, s4, s47
  s_addc_u32 s59, s5, 0
  global_load_dwordx4 a[144:147], v2, s[58:59] offset:0
  global_load_dwordx4 a[148:151], v2, s[58:59] offset:1024
  global_load_dwordx4 a[152:155], v2, s[58:59] offset:2048
  v_cvt_pk_bf16_f32 v182, v108, v109
  v_exp_f32 v112, v112
  v_cvt_pk_bf16_f32 v183, v110, v111
  v_exp_f32 v113, v113
  v_mfma_f32_32x32x16_bf16 v[96:111], v[64:67], v[144:147], 0
  v_exp_f32 v114, v114
  v_exp_f32 v115, v115
  v_exp_f32 v116, v116
  v_exp_f32 v117, v117
  v_cvt_pk_bf16_f32 v184, v112, v113
  v_cvt_pk_bf16_f32 v185, v114, v115
  s_waitcnt vmcnt(6)
  v_mfma_f32_32x32x16_bf16 a[32:47], v[72:75], v[176:179], a[32:47]
  buffer_load_dwordx4 v[88:91], v23, s[8:11], s27 offen sc1
  buffer_load_dwordx4 v[92:95], v23, s[8:11], s27 offen offset:768 sc1
  v_exp_f32 v118, v118
  v_exp_f32 v119, v119
  v_exp_f32 v120, v120
  v_exp_f32 v121, v121
  v_mfma_f32_32x32x8_bf16 v[96:111], v[68:69], v[168:169], v[96:111]
  v_cvt_pk_bf16_f32 v186, v116, v117
  v_exp_f32 v122, v122
  v_exp_f32 v123, v123
  v_cvt_pk_bf16_f32 v187, v118, v119
  v_exp_f32 v124, v124
  v_exp_f32 v125, v125
  v_cvt_pk_bf16_f32 v188, v120, v121
  s_waitcnt vmcnt(7)
  v_mfma_f32_32x32x16_bf16 a[32:47], v[76:79], v[180:183], a[32:47]
  v_exp_f32 v126, v126
  v_exp_f32 v127, v127
  v_cvt_pk_bf16_f32 v189, v122, v123
  s_add_u32 s27, s27, 3072
  global_load_dwordx4 a[156:159], v2, s[58:59] offset:3072
  s_add_u32 s58, s58, 4096
  s_addc_u32 s59, s59, 0
  global_load_dwordx4 a[160:163], v2, s[58:59] offset:0
  global_load_dwordx4 a[164:167], v2, s[58:59] offset:1024
  v_cvt_pk_bf16_f32 v190, v124, v125
  v_exp_f32 v96, v96
  v_cvt_pk_bf16_f32 v191, v126, v127
  v_exp_f32 v97, v97
  v_mfma_f32_32x32x16_bf16 v[112:127], v[64:67], v[148:151], 0
  v_exp_f32 v98, v98
  v_exp_f32 v99, v99
  v_exp_f32 v100, v100
  v_exp_f32 v101, v101
  v_cvt_pk_bf16_f32 v176, v96, v97
  v_cvt_pk_bf16_f32 v177, v98, v99
  v_mfma_f32_32x32x16_bf16 a[48:63], v[72:75], v[184:187], a[48:63]
  v_exp_f32 v102, v102
  v_exp_f32 v103, v103
  v_exp_f32 v104, v104
  v_exp_f32 v105, v105
  v_mfma_f32_32x32x8_bf16 v[112:127], v[68:69], v[170:171], v[112:127]
  v_cvt_pk_bf16_f32 v178, v100, v101
  v_exp_f32 v106, v106
  v_exp_f32 v107, v107
  v_cvt_pk_bf16_f32 v179, v102, v103
  v_exp_f32 v108, v108
  v_exp_f32 v109, v109
  v_cvt_pk_bf16_f32 v180, v104, v105
  v_mfma_f32_32x32x16_bf16 a[48:63], v[76:79], v[188:191], a[48:63]
  v_exp_f32 v110, v110
  v_exp_f32 v111, v111
  v_cvt_pk_bf16_f32 v181, v106, v107
  global_load_dwordx4 a[168:171], v2, s[58:59] offset:2048
  global_load_dwordx4 a[172:175], v2, s[58:59] offset:3072
  s_add_u32 s58, s58, 4096
  s_addc_u32 s59, s59, 0
  global_load_dwordx4 a[176:179], v2, s[58:59] offset:0
  v_cvt_pk_bf16_f32 v182, v108, v109
  v_exp_f32 v112, v112
  v_cvt_pk_bf16_f32 v183, v110, v111
  v_exp_f32 v113, v113
  v_mfma_f32_32x32x16_bf16 v[96:111], v[64:67], v[152:155], 0
  v_exp_f32 v114, v114
  v_exp_f32 v115, v115
  v_exp_f32 v116, v116
  v_exp_f32 v117, v117
  v_cvt_pk_bf16_f32 v184, v112, v113
  v_cvt_pk_bf16_f32 v185, v114, v115
  v_mfma_f32_32x32x16_bf16 a[64:79], v[72:75], v[176:179], a[64:79]
  v_exp_f32 v118, v118
  v_exp_f32 v119, v119
  v_exp_f32 v120, v120
  v_exp_f32 v121, v121
  v_mfma_f32_32x32x8_bf16 v[96:111], v[68:69], v[172:173], v[96:111]
  v_cvt_pk_bf16_f32 v186, v116, v117
  v_exp_f32 v122, v122
  v_exp_f32 v123, v123
  v_cvt_pk_bf16_f32 v187, v118, v119
  v_exp_f32 v124, v124
  v_exp_f32 v125, v125
  v_cvt_pk_bf16_f32 v188, v120, v121
  v_mfma_f32_32x32x16_bf16 a[64:79], v[76:79], v[180:183], a[64:79]
  v_exp_f32 v126, v126
  v_exp_f32 v127, v127
  v_cvt_pk_bf16_f32 v189, v122, v123
  global_load_dwordx4 a[180:183], v2, s[58:59] offset:1024
  global_load_dwordx4 a[184:187], v2, s[58:59] offset:2048
  global_load_dwordx4 a[188:191], v2, s[58:59] offset:3072
  v_cvt_pk_bf16_f32 v190, v124, v125
  v_exp_f32 v96, v96
  v_cvt_pk_bf16_f32 v191, v126, v127
  v_exp_f32 v97, v97
  v_mfma_f32_32x32x16_bf16 v[112:127], v[64:67], v[156:159], 0
  v_exp_f32 v98, v98
  v_exp_f32 v99, v99
  v_exp_f32 v100, v100
  v_exp_f32 v101, v101
  v_cvt_pk_bf16_f32 v176, v96, v97
  v_cvt_pk_bf16_f32 v177, v98, v99
  v_mfma_f32_32x32x16_bf16 a[80:95], v[72:75], v[184:187], a[80:95]
  v_exp_f32 v102, v102
  v_exp_f32 v103, v103
  v_exp_f32 v104, v104
  v_exp_f32 v105, v105
  v_mfma_f32_32x32x8_bf16 v[112:127], v[68:69], v[174:175], v[112:127]
  v_cvt_pk_bf16_f32 v178, v100, v101
  v_exp_f32 v106, v106
  v_exp_f32 v107, v107
  v_cvt_pk_bf16_f32 v179, v102, v103
  v_exp_f32 v108, v108
  v_exp_f32 v109, v109
  v_cvt_pk_bf16_f32 v180, v104, v105
  v_mfma_f32_32x32x16_bf16 a[80:95], v[76:79], v[188:191], a[80:95]
  v_exp_f32 v110, v110
  v_exp_f32 v111, v111
  v_cvt_pk_bf16_f32 v181, v106, v107
  s_add_u32 s58, s58, 4096
  s_addc_u32 s59, s59, 0
  global_load_dwordx4 a[192:195], v2, s[58:59] offset:0
  global_load_dwordx4 a[196:199], v2, s[58:59] offset:1024
  v_cvt_pk_bf16_f32 v182, v108, v109
  v_exp_f32 v112, v112
  v_cvt_pk_bf16_f32 v183, v110, v111
  v_exp_f32 v113, v113
  v_mfma_f32_32x32x16_bf16 v[96:111], v[64:67], v[128:131], 0
  v_exp_f32 v114, v114
  v_exp_f32 v115, v115
  v_exp_f32 v116, v116
  v_exp_f32 v117, v117
  v_cvt_pk_bf16_f32 v184, v112, v113
  v_cvt_pk_bf16_f32 v185, v114, v115
  v_mfma_f32_32x32x16_bf16 a[96:111], v[72:75], v[176:179], a[96:111]
  v_exp_f32 v118, v118
  v_exp_f32 v119, v119
  v_exp_f32 v120, v120
  v_exp_f32 v121, v121
  v_mfma_f32_32x32x8_bf16 v[96:111], v[68:69], v[160:161], v[96:111]
  v_cvt_pk_bf16_f32 v186, v116, v117
  v_exp_f32 v122, v122
  v_exp_f32 v123, v123
  v_cvt_pk_bf16_f32 v187, v118, v119
  v_exp_f32 v124, v124
  v_exp_f32 v125, v125
  v_cvt_pk_bf16_f32 v188, v120, v121
  v_mfma_f32_32x32x16_bf16 a[96:111], v[76:79], v[180:183], a[96:111]
  v_exp_f32 v126, v126
  v_exp_f32 v127, v127
  v_cvt_pk_bf16_f32 v189, v122, v123
  global_load_dwordx4 a[200:203], v2, s[58:59] offset:2048
  global_load_dwordx4 a[204:207], v2, s[58:59] offset:3072
  v_cvt_pk_bf16_f32 v190, v124, v125
  v_exp_f32 v96, v96
  v_cvt_pk_bf16_f32 v191, v126, v127
  v_exp_f32 v97, v97
  v_mfma_f32_32x32x16_bf16 v[112:127], v[64:67], v[132:135], 0
  v_exp_f32 v98, v98
  v_exp_f32 v99, v99
  v_exp_f32 v100, v100
  v_exp_f32 v101, v101
  v_cvt_pk_bf16_f32 v176, v96, v97
  v_cvt_pk_bf16_f32 v177, v98, v99
  v_mfma_f32_32x32x16_bf16 a[112:127], v[72:75], v[184:187], a[112:127]
  v_exp_f32 v102, v102
  v_exp_f32 v103, v103
  v_exp_f32 v104, v104
  v_exp_f32 v105, v105
  v_mfma_f32_32x32x8_bf16 v[112:127], v[68:69], v[162:163], v[112:127]
  v_cvt_pk_bf16_f32 v178, v100, v101
  v_exp_f32 v106, v106
  v_exp_f32 v107, v107
  v_cvt_pk_bf16_f32 v179, v102, v103
  v_exp_f32 v108, v108
  v_exp_f32 v109, v109
  v_cvt_pk_bf16_f32 v180, v104, v105
  v_mfma_f32_32x32x16_bf16 a[112:127], v[76:79], v[188:191], a[112:127]
  v_exp_f32 v110, v110
  v_exp_f32 v111, v111
  v_cvt_pk_bf16_f32 v181, v106, v107
  s_add_u32 s58, s58, 4096
  s_addc_u32 s59, s59, 0
  global_load_dwordx4 a[208:211], v2, s[58:59] offset:0
  global_load_dwordx4 a[212:215], v2, s[58:59] offset:1024
  v_cvt_pk_bf16_f32 v182, v108, v109
  v_exp_f32 v112, v112
  v_cvt_pk_bf16_f32 v183, v110, v111
  v_exp_f32 v113, v113
  s_waitcnt vmcnt(21)
  v_mfma_f32_32x32x16_bf16 v[96:111], v[80:83], v[136:139], 0
  v_exp_f32 v114, v114
  v_exp_f32 v115, v115
  v_exp_f32 v116, v116
  v_exp_f32 v117, v117
  v_cvt_pk_bf16_f32 v184, v112, v113
  v_cvt_pk_bf16_f32 v185, v114, v115
  v_mfma_f32_32x32x16_bf16 a[0:15], v[72:75], v[176:179], a[0:15]
  v_exp_f32 v118, v118
  v_exp_f32 v119, v119
  v_exp_f32 v120, v120
  v_exp_f32 v121, v121
  s_waitcnt vmcnt(20)
  v_mfma_f32_32x32x8_bf16 v[96:111], v[84:85], v[164:165], v[96:111]
  v_cvt_pk_bf16_f32 v186, v116, v117
  v_exp_f32 v122, v122
  v_exp_f32 v123, v123
  v_cvt_pk_bf16_f32 v187, v118, v119
  v_exp_f32 v124, v124
  v_exp_f32 v125, v125
  v_cvt_pk_bf16_f32 v188, v120, v121
  v_mfma_f32_32x32x16_bf16 a[0:15], v[76:79], v[180:183], a[0:15]
  v_exp_f32 v126, v126
  v_exp_f32 v127, v127
  v_cvt_pk_bf16_f32 v189, v122, v123
  global_load_dwordx4 a[216:219], v2, s[58:59] offset:2048
  global_load_dwordx4 a[220:223], v2, s[58:59] offset:3072
  v_cvt_pk_bf16_f32 v190, v124, v125
  v_exp_f32 v96, v96
  v_cvt_pk_bf16_f32 v191, v126, v127
  v_exp_f32 v97, v97
  v_mfma_f32_32x32x16_bf16 v[112:127], v[80:83], v[140:143], 0
  v_exp_f32 v98, v98
  v_exp_f32 v99, v99
  v_exp_f32 v100, v100
  v_exp_f32 v101, v101
  v_cvt_pk_bf16_f32 v176, v96, v97
  v_cvt_pk_bf16_f32 v177, v98, v99
  v_mfma_f32_32x32x16_bf16 a[16:31], v[72:75], v[184:187], a[16:31]
  v_exp_f32 v102, v102
  v_exp_f32 v103, v103
  v_exp_f32 v104, v104
  v_exp_f32 v105, v105
  v_mfma_f32_32x32x8_bf16 v[112:127], v[84:85], v[166:167], v[112:127]
  v_cvt_pk_bf16_f32 v178, v100, v101
  v_exp_f32 v106, v106
  v_exp_f32 v107, v107
  v_cvt_pk_bf16_f32 v179, v102, v103
  v_exp_f32 v108, v108
  v_exp_f32 v109, v109
  v_cvt_pk_bf16_f32 v180, v104, v105
  v_mfma_f32_32x32x16_bf16 a[16:31], v[76:79], v[188:191], a[16:31]
  v_exp_f32 v110, v110
  v_exp_f32 v111, v111
  v_cvt_pk_bf16_f32 v181, v106, v107
  s_add_u32 s58, s58, 4096
  s_addc_u32 s59, s59, 0
  global_load_dwordx4 a[224:227], v2, s[58:59] offset:0
  global_load_dwordx4 a[228:231], v2, s[58:59] offset:1024
  global_load_dwordx4 a[232:235], v2, s[58:59] offset:2048
  global_load_dwordx4 a[236:239], v2, s[58:59] offset:3072
  v_cvt_pk_bf16_f32 v182, v108, v109
  v_exp_f32 v112, v112
  v_cvt_pk_bf16_f32 v183, v110, v111
  v_exp_f32 v113, v113
  v_mfma_f32_32x32x16_bf16 v[96:111], v[80:83], v[144:147], 0
  v_exp_f32 v114, v114
  v_exp_f32 v115, v115
  v_exp_f32 v116, v116
  v_exp_f32 v117, v117
  v_cvt_pk_bf16_f32 v184, v112, v113
  v_cvt_pk_bf16_f32 v185, v114, v115
  s_waitcnt vmcnt(22)
  v_mfma_f32_32x32x16_bf16 a[32:47], v[88:91], v[176:179], a[32:47]
  v_exp_f32 v118, v118
  v_exp_f32 v119, v119
  v_exp_f32 v120, v120
  v_exp_f32 v121, v121
  v_mfma_f32_32x32x8_bf16 v[96:111], v[84:85], v[168:169], v[96:111]
  v_cvt_pk_bf16_f32 v186, v116, v117
  v_exp_f32 v122, v122
  v_exp_f32 v123, v123
  v_cvt_pk_bf16_f32 v187, v118, v119
  v_exp_f32 v124, v124
  v_exp_f32 v125, v125
  v_cvt_pk_bf16_f32 v188, v120, v121
  s_waitcnt vmcnt(21)
  v_mfma_f32_32x32x16_bf16 a[32:47], v[92:95], v[180:183], a[32:47]
  v_exp_f32 v126, v126
  v_exp_f32 v127, v127
  v_cvt_pk_bf16_f32 v189, v122, v123
  s_add_u32 s58, s58, 4096
  s_addc_u32 s59, s59, 0
  global_load_dwordx4 a[240:243], v2, s[58:59] offset:0
  global_load_dwordx4 a[244:247], v2, s[58:59] offset:1024
  global_load_dwordx4 a[248:251], v2, s[58:59] offset:2048
  global_load_dwordx4 a[252:255], v2, s[58:59] offset:3072
  v_cvt_pk_bf16_f32 v190, v124, v125
  v_exp_f32 v96, v96
  v_cvt_pk_bf16_f32 v191, v126, v127
  v_exp_f32 v97, v97
  v_mfma_f32_32x32x16_bf16 v[112:127], v[80:83], v[148:151], 0
  v_exp_f32 v98, v98
  v_exp_f32 v99, v99
  v_exp_f32 v100, v100
  v_exp_f32 v101, v101
  v_cvt_pk_bf16_f32 v176, v96, v97
  v_cvt_pk_bf16_f32 v177, v98, v99
  v_mfma_f32_32x32x16_bf16 a[48:63], v[88:91], v[184:187], a[48:63]
  ds_write_b128 v24, a[32:35] offset:0
  ds_write_b128 v24, a[36:39] offset:1024
  v_exp_f32 v102, v102
  v_exp_f32 v103, v103
  v_exp_f32 v104, v104
  v_exp_f32 v105, v105
  v_mfma_f32_32x32x8_bf16 v[112:127], v[84:85], v[170:171], v[112:127]
  v_cvt_pk_bf16_f32 v178, v100, v101
  v_exp_f32 v106, v106
  v_exp_f32 v107, v107
  v_cvt_pk_bf16_f32 v179, v102, v103
  v_exp_f32 v108, v108
  v_exp_f32 v109, v109
  v_cvt_pk_bf16_f32 v180, v104, v105
  v_mfma_f32_32x32x16_bf16 a[48:63], v[92:95], v[188:191], a[48:63]
  v_exp_f32 v110, v110
  v_exp_f32 v111, v111
  v_cvt_pk_bf16_f32 v181, v106, v107
  ds_write_b128 v24, a[40:43] offset:2048
  v_cvt_pk_bf16_f32 v182, v108, v109
  v_exp_f32 v112, v112
  v_cvt_pk_bf16_f32 v183, v110, v111
  v_exp_f32 v113, v113
  v_mfma_f32_32x32x16_bf16 v[96:111], v[80:83], v[152:155], 0
  v_exp_f32 v114, v114
  v_exp_f32 v115, v115
  v_exp_f32 v116, v116
  v_exp_f32 v117, v117
  v_cvt_pk_bf16_f32 v184, v112, v113
  v_cvt_pk_bf16_f32 v185, v114, v115
  v_mfma_f32_32x32x16_bf16 a[64:79], v[88:91], v[176:179], a[64:79]
  ds_write_b128 v24, a[48:51] offset:3072
  ds_write_b128 v24, a[52:55] offset:4096
  v_exp_f32 v118, v118
  v_exp_f32 v119, v119
  v_exp_f32 v120, v120
  v_exp_f32 v121, v121
  v_mfma_f32_32x32x8_bf16 v[96:111], v[84:85], v[172:173], v[96:111]
  v_cvt_pk_bf16_f32 v186, v116, v117
  v_exp_f32 v122, v122
  v_exp_f32 v123, v123
  v_cvt_pk_bf16_f32 v187, v118, v119
  v_exp_f32 v124, v124
  v_exp_f32 v125, v125
  v_cvt_pk_bf16_f32 v188, v120, v121
  v_mfma_f32_32x32x16_bf16 a[64:79], v[92:95], v[180:183], a[64:79]
  v_exp_f32 v126, v126
  v_exp_f32 v127, v127
  v_cvt_pk_bf16_f32 v189, v122, v123
  ds_write_b128 v24, a[56:59] offset:5120
  v_cvt_pk_bf16_f32 v190, v124, v125
  v_exp_f32 v96, v96
  v_cvt_pk_bf16_f32 v191, v126, v127
  v_exp_f32 v97, v97
  v_mfma_f32_32x32x16_bf16 v[112:127], v[80:83], v[156:159], 0
  v_exp_f32 v98, v98
  v_exp_f32 v99, v99
  v_exp_f32 v100, v100
  v_exp_f32 v101, v101
  v_cvt_pk_bf16_f32 v176, v96, v97
  v_cvt_pk_bf16_f32 v177, v98, v99
  v_mfma_f32_32x32x16_bf16 a[80:95], v[88:91], v[184:187], a[80:95]
  s_waitcnt lgkmcnt(3)
  s_add_u32 s47, s41, 40960
  s_add_u32 s58, s4, s47
  s_addc_u32 s59, s5, 0
  global_load_dwordx4 a[32:35], v2, s[58:59] offset:0
  global_load_dwordx4 a[36:39], v2, s[58:59] offset:1024
  ds_write_b128 v25, a[64:67] offset:0
  ds_write_b128 v25, a[68:71] offset:1024
  v_exp_f32 v102, v102
  v_exp_f32 v103, v103
  v_exp_f32 v104, v104
  v_exp_f32 v105, v105
  v_mfma_f32_32x32x8_bf16 v[112:127], v[84:85], v[174:175], v[112:127]
  v_cvt_pk_bf16_f32 v178, v100, v101
  v_exp_f32 v106, v106
  v_exp_f32 v107, v107
  v_cvt_pk_bf16_f32 v179, v102, v103
  v_exp_f32 v108, v108
  v_exp_f32 v109, v109
  v_cvt_pk_bf16_f32 v180, v104, v105
  v_mfma_f32_32x32x16_bf16 a[80:95], v[92:95], v[188:191], a[80:95]
  v_exp_f32 v110, v110
  v_exp_f32 v111, v111
  v_cvt_pk_bf16_f32 v181, v106, v107
  ds_write_b128 v25, a[72:75] offset:2048
  global_load_dwordx4 a[40:43], v2, s[58:59] offset:2048
  global_load_dwordx4 a[44:47], v2, s[58:59] offset:3072
  v_cvt_pk_bf16_f32 v182, v108, v109
  v_exp_f32 v112, v112
  v_cvt_pk_bf16_f32 v183, v110, v111
  v_exp_f32 v113, v113
  v_mfma_f32_32x32x16_bf16 v[96:111], v[80:83], v[128:131], 0
  v_exp_f32 v114, v114
  v_exp_f32 v115, v115
  v_exp_f32 v116, v116
  v_exp_f32 v117, v117
  v_cvt_pk_bf16_f32 v184, v112, v113
  v_cvt_pk_bf16_f32 v185, v114, v115
  v_mfma_f32_32x32x16_bf16 a[96:111], v[88:91], v[176:179], a[96:111]
  s_waitcnt lgkmcnt(3)
  s_add_u32 s47, s41, 45056
  s_add_u32 s58, s4, s47
  s_addc_u32 s59, s5, 0
  global_load_dwordx4 a[48:51], v2, s[58:59] offset:0
  global_load_dwordx4 a[52:55], v2, s[58:59] offset:1024
  ds_write_b128 v25, a[80:83] offset:3072
  ds_write_b128 v25, a[84:87] offset:4096
  v_exp_f32 v118, v118
  v_exp_f32 v119, v119
  v_exp_f32 v120, v120
  v_exp_f32 v121, v121
  v_mfma_f32_32x32x8_bf16 v[96:111], v[84:85], v[160:161], v[96:111]
  v_cvt_pk_bf16_f32 v186, v116, v117
  v_exp_f32 v122, v122
  v_exp_f32 v123, v123
  v_cvt_pk_bf16_f32 v187, v118, v119
  v_exp_f32 v124, v124
  v_exp_f32 v125, v125
  v_cvt_pk_bf16_f32 v188, v120, v121
  v_mfma_f32_32x32x16_bf16 a[96:111], v[92:95], v[180:183], a[96:111]
  v_exp_f32 v126, v126
  v_exp_f32 v127, v127
  v_cvt_pk_bf16_f32 v189, v122, v123
  ds_write_b128 v25, a[88:91] offset:5120
  global_load_dwordx4 a[56:59], v2, s[58:59] offset:2048
  global_load_dwordx4 a[60:63], v2, s[58:59] offset:3072
  v_cvt_pk_bf16_f32 v190, v124, v125
  v_exp_f32 v96, v96
  v_cvt_pk_bf16_f32 v191, v126, v127
  v_exp_f32 v97, v97
  v_mfma_f32_32x32x16_bf16 v[112:127], v[80:83], v[132:135], 0
  v_exp_f32 v98, v98
  v_exp_f32 v99, v99
  v_exp_f32 v100, v100
  v_exp_f32 v101, v101
  v_cvt_pk_bf16_f32 v176, v96, v97
  v_cvt_pk_bf16_f32 v177, v98, v99
  v_mfma_f32_32x32x16_bf16 a[112:127], v[88:91], v[184:187], a[112:127]
  s_waitcnt lgkmcnt(3)
  s_add_u32 s47, s41, 49152
  s_add_u32 s58, s4, s47
  s_addc_u32 s59, s5, 0
  global_load_dwordx4 a[64:67], v2, s[58:59] offset:0
  global_load_dwordx4 a[68:71], v2, s[58:59] offset:1024
  ds_write_b128 v26, a[96:99] offset:0
  ds_write_b128 v26, a[100:103] offset:1024
  v_exp_f32 v102, v102
  v_exp_f32 v103, v103
  v_exp_f32 v104, v104
  v_exp_f32 v105, v105
  v_mfma_f32_32x32x8_bf16 v[112:127], v[84:85], v[162:163], v[112:127]
  v_cvt_pk_bf16_f32 v178, v100, v101
  v_exp_f32 v106, v106
  v_exp_f32 v107, v107
  v_cvt_pk_bf16_f32 v179, v102, v103
  v_exp_f32 v108, v108
  v_exp_f32 v109, v109
  v_cvt_pk_bf16_f32 v180, v104, v105
  v_mfma_f32_32x32x16_bf16 a[112:127], v[92:95], v[188:191], a[112:127]
  v_exp_f32 v110, v110
  v_exp_f32 v111, v111
  v_cvt_pk_bf16_f32 v181, v106, v107
  ds_write_b128 v26, a[104:107] offset:2048
  global_load_dwordx4 a[72:75], v2, s[58:59] offset:2048
  global_load_dwordx4 a[76:79], v2, s[58:59] offset:3072
  v_cvt_pk_bf16_f32 v182, v108, v109
  v_exp_f32 v112, v112
  v_cvt_pk_bf16_f32 v183, v110, v111
  v_exp_f32 v113, v113
  v_mfma_f32_32x32x16_bf16 v[96:111], v[64:67], v[136:139], 0
  v_exp_f32 v114, v114
  v_exp_f32 v115, v115
  v_exp_f32 v116, v116
  v_exp_f32 v117, v117
  v_cvt_pk_bf16_f32 v184, v112, v113
  v_cvt_pk_bf16_f32 v185, v114, v115
  v_mfma_f32_32x32x16_bf16 a[0:15], v[88:91], v[176:179], a[0:15]
  s_waitcnt lgkmcnt(3)
  s_add_u32 s47, s41, 53248
  s_add_u32 s58, s4, s47
  s_addc_u32 s59, s5, 0
  global_load_dwordx4 a[80:83], v2, s[58:59] offset:0
  global_load_dwordx4 a[84:87], v2, s[58:59] offset:1024
  ds_write_b128 v26, a[112:115] offset:3072
  ds_write_b128 v26, a[116:119] offset:4096
  v_exp_f32 v118, v118
  v_exp_f32 v119, v119
  v_exp_f32 v120, v120
  v_exp_f32 v121, v121
  v_mfma_f32_32x32x8_bf16 v[96:111], v[68:69], v[164:165], v[96:111]
  v_cvt_pk_bf16_f32 v186, v116, v117
  v_exp_f32 v122, v122
  v_exp_f32 v123, v123
  v_cvt_pk_bf16_f32 v187, v118, v119
  v_exp_f32 v124, v124
  v_exp_f32 v125, v125
  v_cvt_pk_bf16_f32 v188, v120, v121
  v_mfma_f32_32x32x16_bf16 a[0:15], v[92:95], v[180:183], a[0:15]
  v_exp_f32 v126, v126
  v_exp_f32 v127, v127
  v_cvt_pk_bf16_f32 v189, v122, v123
  ds_write_b128 v26, a[120:123] offset:5120
  global_load_dwordx4 a[88:91], v2, s[58:59] offset:2048
  global_load_dwordx4 a[92:95], v2, s[58:59] offset:3072
  v_cvt_pk_bf16_f32 v190, v124, v125
  v_cvt_pk_bf16_f32 v191, v126, v127
  v_mfma_f32_32x32x16_bf16 a[16:31], v[88:91], v[184:187], a[16:31]
  s_nop 0
  v_mfma_f32_32x32x16_bf16 a[16:31], v[92:95], v[188:191], a[16:31]
  s_nop 0
  v_accvgpr_read_b32 v192, a0
  v_accvgpr_read_b32 v193, a1
  v_accvgpr_read_b32 v194, a2
  v_accvgpr_read_b32 v195, a3
  v_accvgpr_read_b32 v196, a4
  v_accvgpr_read_b32 v197, a5
  v_accvgpr_read_b32 v198, a6
  v_accvgpr_read_b32 v199, a7
  v_accvgpr_read_b32 v200, a8
  v_accvgpr_read_b32 v201, a9
  v_accvgpr_read_b32 v202, a10
  v_accvgpr_read_b32 v203, a11
  v_accvgpr_read_b32 v204, a16
  v_accvgpr_read_b32 v205, a17
  v_accvgpr_read_b32 v206, a18
  v_accvgpr_read_b32 v207, a19
  v_accvgpr_read_b32 v208, a20
  v_accvgpr_read_b32 v209, a21
  v_accvgpr_read_b32 v210, a22
  v_accvgpr_read_b32 v211, a23
  v_accvgpr_read_b32 v212, a24
  v_accvgpr_read_b32 v213, a25
  v_accvgpr_read_b32 v214, a26
  v_accvgpr_read_b32 v215, a27
  s_waitcnt lgkmcnt(0)
  s_barrier
  ds_read_b128 v[64:67], v31 offset:0
  ds_read_b128 v[68:71], v31 offset:1024
  ds_read_b128 v[72:75], v31 offset:2048
  ds_read_b128 v[76:79], v31 offset:6144
  ds_read_b128 v[80:83], v31 offset:7168
  ds_read_b128 v[84:87], v31 offset:8192
  ds_read_b128 v[88:91], v31 offset:12288
  ds_read_b128 v[92:95], v31 offset:13312
  ds_read_b128 v[96:99], v31 offset:14336
  s_waitcnt lgkmcnt(8)
  v_pk_add_f32 v[192:193], v[192:193], v[64:65]
  v_pk_add_f32 v[194:195], v[194:195], v[66:67]
  s_waitcnt lgkmcnt(7)
  v_pk_add_f32 v[196:197], v[196:197], v[68:69]
  v_pk_add_f32 v[198:199], v[198:199], v[70:71]
  s_waitcnt lgkmcnt(6)
  v_pk_add_f32 v[200:201], v[200:201], v[72:73]
  v_pk_add_f32 v[202:203], v[202:203], v[74:75]
  s_waitcnt lgkmcnt(5)
  v_pk_add_f32 v[192:193], v[192:193], v[76:77]
  v_pk_add_f32 v[194:195], v[194:195], v[78:79]
  s_waitcnt lgkmcnt(4)
  v_pk_add_f32 v[196:197], v[196:197], v[80:81]
  v_pk_add_f32 v[198:199], v[198:199], v[82:83]
  s_waitcnt lgkmcnt(3)
  v_pk_add_f32 v[200:201], v[200:201], v[84:85]
  v_pk_add_f32 v[202:203], v[202:203], v[86:87]
  s_waitcnt lgkmcnt(2)
  v_pk_add_f32 v[192:193], v[192:193], v[88:89]
  v_pk_add_f32 v[194:195], v[194:195], v[90:91]
  s_waitcnt lgkmcnt(1)
  v_pk_add_f32 v[196:197], v[196:197], v[92:93]
  v_pk_add_f32 v[198:199], v[198:199], v[94:95]
  s_waitcnt lgkmcnt(0)
  v_pk_add_f32 v[200:201], v[200:201], v[96:97]
  v_pk_add_f32 v[202:203], v[202:203], v[98:99]
  ds_read_b128 v[64:67], v31 offset:3072
  ds_read_b128 v[68:71], v31 offset:4096
  ds_read_b128 v[72:75], v31 offset:5120
  ds_read_b128 v[76:79], v31 offset:9216
  ds_read_b128 v[80:83], v31 offset:10240
  ds_read_b128 v[84:87], v31 offset:11264
  ds_read_b128 v[88:91], v31 offset:15360
  ds_read_b128 v[92:95], v31 offset:16384
  ds_read_b128 v[96:99], v31 offset:17408
  s_waitcnt lgkmcnt(8)
  v_pk_add_f32 v[204:205], v[204:205], v[64:65]
  v_pk_add_f32 v[206:207], v[206:207], v[66:67]
  s_waitcnt lgkmcnt(7)
  v_pk_add_f32 v[208:209], v[208:209], v[68:69]
  v_pk_add_f32 v[210:211], v[210:211], v[70:71]
  s_waitcnt lgkmcnt(6)
  v_pk_add_f32 v[212:213], v[212:213], v[72:73]
  v_pk_add_f32 v[214:215], v[214:215], v[74:75]
  s_waitcnt lgkmcnt(5)
  v_pk_add_f32 v[204:205], v[204:205], v[76:77]
  v_pk_add_f32 v[206:207], v[206:207], v[78:79]
  s_waitcnt lgkmcnt(4)
  v_pk_add_f32 v[208:209], v[208:209], v[80:81]
  v_pk_add_f32 v[210:211], v[210:211], v[82:83]
  s_waitcnt lgkmcnt(3)
  v_pk_add_f32 v[212:213], v[212:213], v[84:85]
  v_pk_add_f32 v[214:215], v[214:215], v[86:87]
  s_waitcnt lgkmcnt(2)
  v_pk_add_f32 v[204:205], v[204:205], v[88:89]
  v_pk_add_f32 v[206:207], v[206:207], v[90:91]
  s_waitcnt lgkmcnt(1)
  v_pk_add_f32 v[208:209], v[208:209], v[92:93]
  v_pk_add_f32 v[210:211], v[210:211], v[94:95]
  s_waitcnt lgkmcnt(0)
  v_pk_add_f32 v[212:213], v[212:213], v[96:97]
  v_pk_add_f32 v[214:215], v[214:215], v[98:99]
  v_mov_b32 v28, v200
  v_mov_b32 v6, v200
  s_nop 1
  v_permlane32_swap_b32 v6, v28
  v_mov_b32 v30, v212
  v_mov_b32 v6, v212
  s_nop 1
  v_permlane32_swap_b32 v6, v30
  v_mov_b32 v8, 0x5d800000
  v_cmp_nlt_f32 s[48:49], v28, v8
  v_cmp_nlt_f32 s[50:51], v30, v8
  v_mov_b32 v34, 0
  v_mov_b32 v35, 0
  v_pk_fma_f32 v[34:35], v[192:193], 0, v[34:35] op_sel_hi:[1,0,1]
  v_pk_fma_f32 v[34:35], v[194:195], 0, v[34:35] op_sel_hi:[1,0,1]
  v_pk_fma_f32 v[34:35], v[196:197], 0, v[34:35] op_sel_hi:[1,0,1]
  v_pk_fma_f32 v[34:35], v[198:199], 0, v[34:35] op_sel_hi:[1,0,1]
  v_pk_fma_f32 v[34:35], v[200:201], 0, v[34:35] op_sel_hi:[1,0,1]
  v_pk_fma_f32 v[34:35], v[202:203], 0, v[34:35] op_sel_hi:[1,0,1]
  v_pk_fma_f32 v[34:35], v[204:205], 0, v[34:35] op_sel_hi:[1,0,1]
  v_pk_fma_f32 v[34:35], v[206:207], 0, v[34:35] op_sel_hi:[1,0,1]
  v_pk_fma_f32 v[34:35], v[208:209], 0, v[34:35] op_sel_hi:[1,0,1]
  v_pk_fma_f32 v[34:35], v[210:211], 0, v[34:35] op_sel_hi:[1,0,1]
  v_pk_fma_f32 v[34:35], v[212:213], 0, v[34:35] op_sel_hi:[1,0,1]
  v_pk_fma_f32 v[34:35], v[214:215], 0, v[34:35] op_sel_hi:[1,0,1]
  v_rcp_f32 v28, v28
  v_rcp_f32 v30, v30
  v_add_f32 v34, v34, v35
  v_cmp_u_f32 vcc, v34, v34
  v_pk_mul_f32 v[192:193], v[192:193], v[28:29] op_sel_hi:[1,0]
  v_pk_mul_f32 v[194:195], v[194:195], v[28:29] op_sel_hi:[1,0]
  v_pk_mul_f32 v[196:197], v[196:197], v[28:29] op_sel_hi:[1,0]
  v_pk_mul_f32 v[198:199], v[198:199], v[28:29] op_sel_hi:[1,0]
  v_pk_mul_f32 v[200:201], v[200:201], v[28:29] op_sel_hi:[1,0]
  v_pk_mul_f32 v[202:203], v[202:203], v[28:29] op_sel_hi:[1,0]
  v_cvt_pk_bf16_f32 v176, v192, v193
  v_cvt_pk_bf16_f32 v177, v194, v195
  v_cvt_pk_bf16_f32 v178, v196, v197
  v_cvt_pk_bf16_f32 v179, v198, v199
  v_cvt_pk_bf16_f32 v180, v200, v201
  v_cvt_pk_bf16_f32 v181, v202, v203
  ds_write_b64 v219, v[176:177] offset:0
  ds_write_b64 v219, v[178:179] offset:1024
  ds_write_b64 v219, v[180:181] offset:2048
  v_pk_mul_f32 v[204:205], v[204:205], v[30:31] op_sel_hi:[1,0]
  v_pk_mul_f32 v[206:207], v[206:207], v[30:31] op_sel_hi:[1,0]
  v_pk_mul_f32 v[208:209], v[208:209], v[30:31] op_sel_hi:[1,0]
  v_pk_mul_f32 v[210:211], v[210:211], v[30:31] op_sel_hi:[1,0]
  v_pk_mul_f32 v[212:213], v[212:213], v[30:31] op_sel_hi:[1,0]
  v_pk_mul_f32 v[214:215], v[214:215], v[30:31] op_sel_hi:[1,0]
  v_cvt_pk_bf16_f32 v184, v204, v205
  v_cvt_pk_bf16_f32 v185, v206, v207
  v_cvt_pk_bf16_f32 v186, v208, v209
  v_cvt_pk_bf16_f32 v187, v210, v211
  v_cvt_pk_bf16_f32 v188, v212, v213
  v_cvt_pk_bf16_f32 v189, v214, v215
  ds_write_b64 v219, v[184:185] offset:256
  ds_write_b64 v219, v[186:187] offset:1280
  ds_write_b64 v219, v[188:189] offset:2304
  s_or_b64 s[48:49], s[48:49], s[50:51]
  s_or_b64 s[48:49], s[48:49], vcc
  s_cmp_lg_u64 s[48:49], 0
  s_cselect_b32 s21, 1, 0
  s_cmp_eq_u32 s29, 1
  s_cselect_b32 s21, 0, s21
  v_mov_b32 v6, s21
  ds_write_b32 v218, v6
  s_waitcnt lgkmcnt(0)
  s_barrier
  v_mov_b32 v7, 162304
  ds_read_b128 v[34:37], v7
  ds_read_b64 v[64:65], v221
  ds_read_b64 v[66:67], v222
  ds_read_b64 v[68:69], v223
  ds_read_b64 v[70:71], v224
  ds_read_b64 v[72:73], v225
  ds_read_b64 v[74:75], v226
  s_waitcnt lgkmcnt(6)
  v_or_b32 v34, v34, v35
  v_or_b32 v36, v36, v37
  v_or_b32 v34, v34, v36
  s_nop 0
  v_readfirstlane_b32 s21, v34
  s_nop 3
  s_cmp_eq_u32 s21, 0
  s_cbranch_scc1 ATT_OK_a
  s_mov_b32 s29, 1
  s_waitcnt vmcnt(0)
  v_mov_b32 v192, 0xff61b1e6
  v_mov_b32 v193, 0xff61b1e6
  v_mov_b32 v194, 0xff61b1e6
  v_mov_b32 v195, 0xff61b1e6
  v_mov_b32 v196, 0xff61b1e6
  v_mov_b32 v197, 0xff61b1e6
  v_mov_b32 v198, 0xff61b1e6
  v_mov_b32 v199, 0xff61b1e6
  s_mov_b32 s27, s26
  s_mov_b32 s28, 16
ATT_MAX_a:
  s_waitcnt lgkmcnt(4)
  buffer_load_dwordx4 v[64:67], v2, s[8:11], s27 offen sc1
  s_waitcnt lgkmcnt(3)
  buffer_load_dwordx2 v[68:69], v22, s[8:11], s27 offen sc1
  s_add_u32 s27, s27, 3072
  v_cmp_gt_u32 vcc, 32, v1
  s_nop 1
  v_cndmask_b32 v200, 0, v160, vcc
  v_cndmask_b32 v201, 0, v161, vcc
  s_waitcnt vmcnt(1)
  v_mfma_f32_32x32x16_bf16 v[96:111], v[64:67], v[128:131], 0
  s_nop 9
  s_waitcnt vmcnt(0)
  v_mfma_f32_32x32x8_bf16 v[96:111], v[68:69], v[200:201], v[96:111]
  s_nop 11
  v_max3_f32 v192, v192, v96, v97
  v_max3_f32 v192, v192, v98, v99
  v_max3_f32 v192, v192, v100, v101
  v_max3_f32 v192, v192, v102, v103
  v_max3_f32 v192, v192, v104, v105
  v_max3_f32 v192, v192, v106, v107
  v_max3_f32 v192, v192, v108, v109
  v_max3_f32 v192, v192, v110, v111
  v_cndmask_b32 v200, 0, v162, vcc
  v_cndmask_b32 v201, 0, v163, vcc
  v_mfma_f32_32x32x16_bf16 v[96:111], v[64:67], v[132:135], 0
  s_nop 9
  v_mfma_f32_32x32x8_bf16 v[96:111], v[68:69], v[200:201], v[96:111]
  s_nop 11
  v_max3_f32 v193, v193, v96, v97
  v_max3_f32 v193, v193, v98, v99
  v_max3_f32 v193, v193, v100, v101
  v_max3_f32 v193, v193, v102, v103
  v_max3_f32 v193, v193, v104, v105
  v_max3_f32 v193, v193, v106, v107
  v_max3_f32 v193, v193, v108, v109
  v_max3_f32 v193, v193, v110, v111
  v_cndmask_b32 v200, 0, v164, vcc
  v_cndmask_b32 v201, 0, v165, vcc
  v_mfma_f32_32x32x16_bf16 v[96:111], v[64:67], v[136:139], 0
  s_nop 9
  v_mfma_f32_32x32x8_bf16 v[96:111], v[68:69], v[200:201], v[96:111]
  s_nop 11
  v_max3_f32 v194, v194, v96, v97
  v_max3_f32 v194, v194, v98, v99
  v_max3_f32 v194, v194, v100, v101
  v_max3_f32 v194, v194, v102, v103
  v_max3_f32 v194, v194, v104, v105
  v_max3_f32 v194, v194, v106, v107
  v_max3_f32 v194, v194, v108, v109
  v_max3_f32 v194, v194, v110, v111
  v_cndmask_b32 v200, 0, v166, vcc
  v_cndmask_b32 v201, 0, v167, vcc
  v_mfma_f32_32x32x16_bf16 v[96:111], v[64:67], v[140:143], 0
  s_nop 9
  v_mfma_f32_32x32x8_bf16 v[96:111], v[68:69], v[200:201], v[96:111]
  s_nop 11
  v_max3_f32 v195, v195, v96, v97
  v_max3_f32 v195, v195, v98, v99
  v_max3_f32 v195, v195, v100, v101
  v_max3_f32 v195, v195, v102, v103
  v_max3_f32 v195, v195, v104, v105
  v_max3_f32 v195, v195, v106, v107
  v_max3_f32 v195, v195, v108, v109
  v_max3_f32 v195, v195, v110, v111
  v_cndmask_b32 v200, 0, v168, vcc
  v_cndmask_b32 v201, 0, v169, vcc
  v_mfma_f32_32x32x16_bf16 v[96:111], v[64:67], v[144:147], 0
  s_nop 9
  v_mfma_f32_32x32x8_bf16 v[96:111], v[68:69], v[200:201], v[96:111]
  s_nop 11
  v_max3_f32 v196, v196, v96, v97
  v_max3_f32 v196, v196, v98, v99
  v_max3_f32 v196, v196, v100, v101
  v_max3_f32 v196, v196, v102, v103
  v_max3_f32 v196, v196, v104, v105
  v_max3_f32 v196, v196, v106, v107
  v_max3_f32 v196, v196, v108, v109
  v_max3_f32 v196, v196, v110, v111
  v_cndmask_b32 v200, 0, v170, vcc
  v_cndmask_b32 v201, 0, v171, vcc
  v_mfma_f32_32x32x16_bf16 v[96:111], v[64:67], v[148:151], 0
  s_nop 9
  v_mfma_f32_32x32x8_bf16 v[96:111], v[68:69], v[200:201], v[96:111]
  s_nop 11
  v_max3_f32 v197, v197, v96, v97
  v_max3_f32 v197, v197, v98, v99
  v_max3_f32 v197, v197, v100, v101
  v_max3_f32 v197, v197, v102, v103
  v_max3_f32 v197, v197, v104, v105
  v_max3_f32 v197, v197, v106, v107
  v_max3_f32 v197, v197, v108, v109
  v_max3_f32 v197, v197, v110, v111
  v_cndmask_b32 v200, 0, v172, vcc
  v_cndmask_b32 v201, 0, v173, vcc
  v_mfma_f32_32x32x16_bf16 v[96:111], v[64:67], v[152:155], 0
  s_nop 9
  v_mfma_f32_32x32x8_bf16 v[96:111], v[68:69], v[200:201], v[96:111]
  s_nop 11
  v_max3_f32 v198, v198, v96, v97
  v_max3_f32 v198, v198, v98, v99
  v_max3_f32 v198, v198, v100, v101
  v_max3_f32 v198, v198, v102, v103
  v_max3_f32 v198, v198, v104, v105
  v_max3_f32 v198, v198, v106, v107
  v_max3_f32 v198, v198, v108, v109
  v_max3_f32 v198, v198, v110, v111
  v_cndmask_b32 v200, 0, v174, vcc
  v_cndmask_b32 v201, 0, v175, vcc
  v_mfma_f32_32x32x16_bf16 v[96:111], v[64:67], v[156:159], 0
  s_nop 9
  v_mfma_f32_32x32x8_bf16 v[96:111], v[68:69], v[200:201], v[96:111]
  s_nop 11
  v_max3_f32 v199, v199, v96, v97
  v_max3_f32 v199, v199, v98, v99
  v_max3_f32 v199, v199, v100, v101
  v_max3_f32 v199, v199, v102, v103
  v_max3_f32 v199, v199, v104, v105
  v_max3_f32 v199, v199, v106, v107
  v_max3_f32 v199, v199, v108, v109
  v_max3_f32 v199, v199, v110, v111
  s_sub_u32 s28, s28, 1
  s_cmp_lg_u32 s28, 0
  s_cbranch_scc1 ATT_MAX_a
  s_barrier
  v_mov_b32 v6, v192
  s_nop 1
  v_permlane32_swap_b32 v192, v6
  v_max_f32 v192, v192, v6
  s_add_u32 s21, s18, 0
  s_and_b32 s21, s21, 3
  s_lshl_b32 s21, s21, 9
  s_lshl_b32 s22, s18, 11
  s_add_u32 s21, s21, s22
  s_add_u32 s21, s21, 86016
  v_lshlrev_b32 v7, 2, v1
  v_add_u32 v7, s21, v7
  ds_write_b32 v7, v192
  v_mov_b32 v6, v193
  s_nop 1
  v_permlane32_swap_b32 v193, v6
  v_max_f32 v193, v193, v6
  s_add_u32 s21, s18, 0
  s_and_b32 s21, s21, 3
  s_lshl_b32 s21, s21, 9
  s_lshl_b32 s22, s18, 11
  s_add_u32 s21, s21, s22
  s_add_u32 s21, s21, 86272
  v_lshlrev_b32 v7, 2, v1
  v_add_u32 v7, s21, v7
  ds_write_b32 v7, v193
  v_mov_b32 v6, v194
  s_nop 1
  v_permlane32_swap_b32 v194, v6
  v_max_f32 v194, v194, v6
  s_add_u32 s21, s18, 1
  s_and_b32 s21, s21, 3
  s_lshl_b32 s21, s21, 9
  s_lshl_b32 s22, s18, 11
  s_add_u32 s21, s21, s22
  s_add_u32 s21, s21, 86016
  v_lshlrev_b32 v7, 2, v1
  v_add_u32 v7, s21, v7
  ds_write_b32 v7, v194
  v_mov_b32 v6, v195
  s_nop 1
  v_permlane32_swap_b32 v195, v6
  v_max_f32 v195, v195, v6
  s_add_u32 s21, s18, 1
  s_and_b32 s21, s21, 3
  s_lshl_b32 s21, s21, 9
  s_lshl_b32 s22, s18, 11
  s_add_u32 s21, s21, s22
  s_add_u32 s21, s21, 86272
  v_lshlrev_b32 v7, 2, v1
  v_add_u32 v7, s21, v7
  ds_write_b32 v7, v195
  v_mov_b32 v6, v196
  s_nop 1
  v_permlane32_swap_b32 v196, v6
  v_max_f32 v196, v196, v6
  s_add_u32 s21, s18, 2
  s_and_b32 s21, s21, 3
  s_lshl_b32 s21, s21, 9
  s_lshl_b32 s22, s18, 11
  s_add_u32 s21, s21, s22
  s_add_u32 s21, s21, 86016
  v_lshlrev_b32 v7, 2, v1
  v_add_u32 v7, s21, v7
  ds_write_b32 v7, v196
  v_mov_b32 v6, v197
  s_nop 1
  v_permlane32_swap_b32 v197, v6
  v_max_f32 v197, v197, v6
  s_add_u32 s21, s18, 2
  s_and_b32 s21, s21, 3
  s_lshl_b32 s21, s21, 9
  s_lshl_b32 s22, s18, 11
  s_add_u32 s21, s21, s22
  s_add_u32 s21, s21, 86272
  v_lshlrev_b32 v7, 2, v1
  v_add_u32 v7, s21, v7
  ds_write_b32 v7, v197
  v_mov_b32 v6, v198
  s_nop 1
  v_permlane32_swap_b32 v198, v6
  v_max_f32 v198, v198, v6
  s_add_u32 s21, s18, 3
  s_and_b32 s21, s21, 3
  s_lshl_b32 s21, s21, 9
  s_lshl_b32 s22, s18, 11
  s_add_u32 s21, s21, s22
  s_add_u32 s21, s21, 86016
  v_lshlrev_b32 v7, 2, v1
  v_add_u32 v7, s21, v7
  ds_write_b32 v7, v198
  v_mov_b32 v6, v199
  s_nop 1
  v_permlane32_swap_b32 v199, v6
  v_max_f32 v199, v199, v6
  s_add_u32 s21, s18, 3
  s_and_b32 s21, s21, 3
  s_lshl_b32 s21, s21, 9
  s_lshl_b32 s22, s18, 11
  s_add_u32 s21, s21, s22
  s_add_u32 s21, s21, 86272
  v_lshlrev_b32 v7, 2, v1
  v_add_u32 v7, s21, v7
  ds_write_b32 v7, v199
  s_waitcnt lgkmcnt(0)
  s_barrier
  s_add_u32 s21, s18, 0
  s_and_b32 s21, s21, 3
  s_lshl_b32 s21, s21, 9
  s_add_u32 s21, s21, 86016
  v_lshlrev_b32 v7, 2, v1
  v_add_u32 v7, s21, v7
  ds_read_b32 v204, v7 offset:0
  ds_read_b32 v205, v7 offset:2048
  ds_read_b32 v206, v7 offset:4096
  ds_read_b32 v207, v7 offset:6144
  s_waitcnt lgkmcnt(1)
  v_max3_f32 v204, v204, v205, v206
  s_waitcnt lgkmcnt(0)
  v_max_f32 v204, v204, v207
  v_sub_f32 v6, 0, v204
  v_and_b32 v8, 0xffff0000, v6
  v_sub_f32 v6, v6, v8
  v_and_b32 v9, 0xffff0000, v6
  v_sub_f32 v6, v6, v9
  v_lshrrev_b32 v8, 16, v8
  v_or_b32 v8, v8, v9
  v_lshrrev_b32 v6, 16, v6
  v_cmp_gt_u32 vcc, 32, v1
  s_nop 1
  v_cndmask_b32 v160, v8, v160, vcc
  v_cndmask_b32 v161, v6, v161, vcc
  s_add_u32 s21, s18, 0
  s_and_b32 s21, s21, 3
  s_lshl_b32 s21, s21, 9
  s_add_u32 s21, s21, 86272
  v_lshlrev_b32 v7, 2, v1
  v_add_u32 v7, s21, v7
  ds_read_b32 v204, v7 offset:0
  ds_read_b32 v205, v7 offset:2048
  ds_read_b32 v206, v7 offset:4096
  ds_read_b32 v207, v7 offset:6144
  s_waitcnt lgkmcnt(1)
  v_max3_f32 v204, v204, v205, v206
  s_waitcnt lgkmcnt(0)
  v_max_f32 v204, v204, v207
  v_sub_f32 v6, 0, v204
  v_and_b32 v8, 0xffff0000, v6
  v_sub_f32 v6, v6, v8
  v_and_b32 v9, 0xffff0000, v6
  v_sub_f32 v6, v6, v9
  v_lshrrev_b32 v8, 16, v8
  v_or_b32 v8, v8, v9
  v_lshrrev_b32 v6, 16, v6
  v_cmp_gt_u32 vcc, 32, v1
  s_nop 1
  v_cndmask_b32 v162, v8, v162, vcc
  v_cndmask_b32 v163, v6, v163, vcc
  s_add_u32 s21, s18, 1
  s_and_b32 s21, s21, 3
  s_lshl_b32 s21, s21, 9
  s_add_u32 s21, s21, 86016
  v_lshlrev_b32 v7, 2, v1
  v_add_u32 v7, s21, v7
  ds_read_b32 v204, v7 offset:0
  ds_read_b32 v205, v7 offset:2048
  ds_read_b32 v206, v7 offset:4096
  ds_read_b32 v207, v7 offset:6144
  s_waitcnt lgkmcnt(1)
  v_max3_f32 v204, v204, v205, v206
  s_waitcnt lgkmcnt(0)
  v_max_f32 v204, v204, v207
  v_sub_f32 v6, 0, v204
  v_and_b32 v8, 0xffff0000, v6
  v_sub_f32 v6, v6, v8
  v_and_b32 v9, 0xffff0000, v6
  v_sub_f32 v6, v6, v9
  v_lshrrev_b32 v8, 16, v8
  v_or_b32 v8, v8, v9
  v_lshrrev_b32 v6, 16, v6
  v_cmp_gt_u32 vcc, 32, v1
  s_nop 1
  v_cndmask_b32 v164, v8, v164, vcc
  v_cndmask_b32 v165, v6, v165, vcc
  s_add_u32 s21, s18, 1
  s_and_b32 s21, s21, 3
  s_lshl_b32 s21, s21, 9
  s_add_u32 s21, s21, 86272
  v_lshlrev_b32 v7, 2, v1
  v_add_u32 v7, s21, v7
  ds_read_b32 v204, v7 offset:0
  ds_read_b32 v205, v7 offset:2048
  ds_read_b32 v206, v7 offset:4096
  ds_read_b32 v207, v7 offset:6144
  s_waitcnt lgkmcnt(1)
  v_max3_f32 v204, v204, v205, v206
  s_waitcnt lgkmcnt(0)
  v_max_f32 v204, v204, v207
  v_sub_f32 v6, 0, v204
  v_and_b32 v8, 0xffff0000, v6
  v_sub_f32 v6, v6, v8
  v_and_b32 v9, 0xffff0000, v6
  v_sub_f32 v6, v6, v9
  v_lshrrev_b32 v8, 16, v8
  v_or_b32 v8, v8, v9
  v_lshrrev_b32 v6, 16, v6
  v_cmp_gt_u32 vcc, 32, v1
  s_nop 1
  v_cndmask_b32 v166, v8, v166, vcc
  v_cndmask_b32 v167, v6, v167, vcc
  s_add_u32 s21, s18, 2
  s_and_b32 s21, s21, 3
  s_lshl_b32 s21, s21, 9
  s_add_u32 s21, s21, 86016
  v_lshlrev_b32 v7, 2, v1
  v_add_u32 v7, s21, v7
  ds_read_b32 v204, v7 offset:0
  ds_read_b32 v205, v7 offset:2048
  ds_read_b32 v206, v7 offset:4096
  ds_read_b32 v207, v7 offset:6144
  s_waitcnt lgkmcnt(1)
  v_max3_f32 v204, v204, v205, v206
  s_waitcnt lgkmcnt(0)
  v_max_f32 v204, v204, v207
  v_sub_f32 v6, 0, v204
  v_and_b32 v8, 0xffff0000, v6
  v_sub_f32 v6, v6, v8
  v_and_b32 v9, 0xffff0000, v6
  v_sub_f32 v6, v6, v9
  v_lshrrev_b32 v8, 16, v8
  v_or_b32 v8, v8, v9
  v_lshrrev_b32 v6, 16, v6
  v_cmp_gt_u32 vcc, 32, v1
  s_nop 1
  v_cndmask_b32 v168, v8, v168, vcc
  v_cndmask_b32 v169, v6, v169, vcc
  s_add_u32 s21, s18, 2
  s_and_b32 s21, s21, 3
  s_lshl_b32 s21, s21, 9
  s_add_u32 s21, s21, 86272
  v_lshlrev_b32 v7, 2, v1
  v_add_u32 v7, s21, v7
  ds_read_b32 v204, v7 offset:0
  ds_read_b32 v205, v7 offset:2048
  ds_read_b32 v206, v7 offset:4096
  ds_read_b32 v207, v7 offset:6144
  s_waitcnt lgkmcnt(1)
  v_max3_f32 v204, v204, v205, v206
  s_waitcnt lgkmcnt(0)
  v_max_f32 v204, v204, v207
  v_sub_f32 v6, 0, v204
  v_and_b32 v8, 0xffff0000, v6
  v_sub_f32 v6, v6, v8
  v_and_b32 v9, 0xffff0000, v6
  v_sub_f32 v6, v6, v9
  v_lshrrev_b32 v8, 16, v8
  v_or_b32 v8, v8, v9
  v_lshrrev_b32 v6, 16, v6
  v_cmp_gt_u32 vcc, 32, v1
  s_nop 1
  v_cndmask_b32 v170, v8, v170, vcc
  v_cndmask_b32 v171, v6, v171, vcc
  s_add_u32 s21, s18, 3
  s_and_b32 s21, s21, 3
  s_lshl_b32 s21, s21, 9
  s_add_u32 s21, s21, 86016
  v_lshlrev_b32 v7, 2, v1
  v_add_u32 v7, s21, v7
  ds_read_b32 v204, v7 offset:0
  ds_read_b32 v205, v7 offset:2048
  ds_read_b32 v206, v7 offset:4096
  ds_read_b32 v207, v7 offset:6144
  s_waitcnt lgkmcnt(1)
  v_max3_f32 v204, v204, v205, v206
  s_waitcnt lgkmcnt(0)
  v_max_f32 v204, v204, v207
  v_sub_f32 v6, 0, v204
  v_and_b32 v8, 0xffff0000, v6
  v_sub_f32 v6, v6, v8
  v_and_b32 v9, 0xffff0000, v6
  v_sub_f32 v6, v6, v9
  v_lshrrev_b32 v8, 16, v8
  v_or_b32 v8, v8, v9
  v_lshrrev_b32 v6, 16, v6
  v_cmp_gt_u32 vcc, 32, v1
  s_nop 1
  v_cndmask_b32 v172, v8, v172, vcc
  v_cndmask_b32 v173, v6, v173, vcc
  s_add_u32 s21, s18, 3
  s_and_b32 s21, s21, 3
  s_lshl_b32 s21, s21, 9
  s_add_u32 s21, s21, 86272
  v_lshlrev_b32 v7, 2, v1
  v_add_u32 v7, s21, v7
  ds_read_b32 v204, v7 offset:0
  ds_read_b32 v205, v7 offset:2048
  ds_read_b32 v206, v7 offset:4096
  ds_read_b32 v207, v7 offset:6144
  s_waitcnt lgkmcnt(1)
  v_max3_f32 v204, v204, v205, v206
  s_waitcnt lgkmcnt(0)
  v_max_f32 v204, v204, v207
  v_sub_f32 v6, 0, v204
  v_and_b32 v8, 0xffff0000, v6
  v_sub_f32 v6, v6, v8
  v_and_b32 v9, 0xffff0000, v6
  v_sub_f32 v6, v6, v9
  v_lshrrev_b32 v8, 16, v8
  v_or_b32 v8, v8, v9
  v_lshrrev_b32 v6, 16, v6
  v_cmp_gt_u32 vcc, 32, v1
  s_nop 1
  v_cndmask_b32 v174, v8, v174, vcc
  v_cndmask_b32 v175, v6, v175, vcc
  v_accvgpr_write_b32 a0, 0
  v_accvgpr_write_b32 a1, 0
  v_accvgpr_write_b32 a2, 0
  v_accvgpr_write_b32 a3, 0
  v_accvgpr_write_b32 a4, 0
  v_accvgpr_write_b32 a5, 0
  v_accvgpr_write_b32 a6, 0
  v_accvgpr_write_b32 a7, 0
  v_accvgpr_write_b32 a8, 0
  v_accvgpr_write_b32 a9, 0
  v_accvgpr_write_b32 a10, 0
  v_accvgpr_write_b32 a11, 0
  v_accvgpr_write_b32 a12, 0
  v_accvgpr_write_b32 a13, 0
  v_accvgpr_write_b32 a14, 0
  v_accvgpr_write_b32 a15, 0
  v_accvgpr_write_b32 a16, 0
  v_accvgpr_write_b32 a17, 0
  v_accvgpr_write_b32 a18, 0
  v_accvgpr_write_b32 a19, 0
  v_accvgpr_write_b32 a20, 0
  v_accvgpr_write_b32 a21, 0
  v_accvgpr_write_b32 a22, 0
  v_accvgpr_write_b32 a23, 0
  v_accvgpr_write_b32 a24, 0
  v_accvgpr_write_b32 a25, 0
  v_accvgpr_write_b32 a26, 0
  v_accvgpr_write_b32 a27, 0
  v_accvgpr_write_b32 a28, 0
  v_accvgpr_write_b32 a29, 0
  v_accvgpr_write_b32 a30, 0
  v_accvgpr_write_b32 a31, 0
  v_accvgpr_write_b32 a32, 0
  v_accvgpr_write_b32 a33, 0
  v_accvgpr_write_b32 a34, 0
  v_accvgpr_write_b32 a35, 0
  v_accvgpr_write_b32 a36, 0
  v_accvgpr_write_b32 a37, 0
  v_accvgpr_write_b32 a38, 0
  v_accvgpr_write_b32 a39, 0
  v_accvgpr_write_b32 a40, 0
  v_accvgpr_write_b32 a41, 0
  v_accvgpr_write_b32 a42, 0
  v_accvgpr_write_b32 a43, 0
  v_accvgpr_write_b32 a44, 0
  v_accvgpr_write_b32 a45, 0
  v_accvgpr_write_b32 a46, 0
  v_accvgpr_write_b32 a47, 0
  v_accvgpr_write_b32 a48, 0
  v_accvgpr_write_b32 a49, 0
  v_accvgpr_write_b32 a50, 0
  v_accvgpr_write_b32 a51, 0
  v_accvgpr_write_b32 a52, 0
  v_accvgpr_write_b32 a53, 0
  v_accvgpr_write_b32 a54, 0
  v_accvgpr_write_b32 a55, 0
  v_accvgpr_write_b32 a56, 0
  v_accvgpr_write_b32 a57, 0
  v_accvgpr_write_b32 a58, 0
  v_accvgpr_write_b32 a59, 0
  v_accvgpr_write_b32 a60, 0
  v_accvgpr_write_b32 a61, 0
  v_accvgpr_write_b32 a62, 0
  v_accvgpr_write_b32 a63, 0
  v_accvgpr_write_b32 a64, 0
  v_accvgpr_write_b32 a65, 0
  v_accvgpr_write_b32 a66, 0
  v_accvgpr_write_b32 a67, 0
  v_accvgpr_write_b32 a68, 0
  v_accvgpr_write_b32 a69, 0
  v_accvgpr_write_b32 a70, 0
  v_accvgpr_write_b32 a71, 0
  v_accvgpr_write_b32 a72, 0
  v_accvgpr_write_b32 a73, 0
  v_accvgpr_write_b32 a74, 0
  v_accvgpr_write_b32 a75, 0
  v_accvgpr_write_b32 a76, 0
  v_accvgpr_write_b32 a77, 0
  v_accvgpr_write_b32 a78, 0
  v_accvgpr_write_b32 a79, 0
  v_accvgpr_write_b32 a80, 0
  v_accvgpr_write_b32 a81, 0
  v_accvgpr_write_b32 a82, 0
  v_accvgpr_write_b32 a83, 0
  v_accvgpr_write_b32 a84, 0
  v_accvgpr_write_b32 a85, 0
  v_accvgpr_write_b32 a86, 0
  v_accvgpr_write_b32 a87, 0
  v_accvgpr_write_b32 a88, 0
  v_accvgpr_write_b32 a89, 0
  v_accvgpr_write_b32 a90, 0
  v_accvgpr_write_b32 a91, 0
  v_accvgpr_write_b32 a92, 0
  v_accvgpr_write_b32 a93, 0
  v_accvgpr_write_b32 a94, 0
  v_accvgpr_write_b32 a95, 0
  v_accvgpr_write_b32 a96, 0
  v_accvgpr_write_b32 a97, 0
  v_accvgpr_write_b32 a98, 0
  v_accvgpr_write_b32 a99, 0
  v_accvgpr_write_b32 a100, 0
  v_accvgpr_write_b32 a101, 0
  v_accvgpr_write_b32 a102, 0
  v_accvgpr_write_b32 a103, 0
  v_accvgpr_write_b32 a104, 0
  v_accvgpr_write_b32 a105, 0
  v_accvgpr_write_b32 a106, 0
  v_accvgpr_write_b32 a107, 0
  v_accvgpr_write_b32 a108, 0
  v_accvgpr_write_b32 a109, 0
  v_accvgpr_write_b32 a110, 0
  v_accvgpr_write_b32 a111, 0
  v_accvgpr_write_b32 a112, 0
  v_accvgpr_write_b32 a113, 0
  v_accvgpr_write_b32 a114, 0
  v_accvgpr_write_b32 a115, 0
  v_accvgpr_write_b32 a116, 0
  v_accvgpr_write_b32 a117, 0
  v_accvgpr_write_b32 a118, 0
  v_accvgpr_write_b32 a119, 0
  v_accvgpr_write_b32 a120, 0
  v_accvgpr_write_b32 a121, 0
  v_accvgpr_write_b32 a122, 0
  v_accvgpr_write_b32 a123, 0
  v_accvgpr_write_b32 a124, 0
  v_accvgpr_write_b32 a125, 0
  v_accvgpr_write_b32 a126, 0
  v_accvgpr_write_b32 a127, 0
  s_waitcnt lgkmcnt(0)
  s_barrier
  s_branch ATT_RUN_a
ATT_OK_a:
  s_nop 1
  s_waitcnt lgkmcnt(0)
  buffer_store_dwordx4 v[64:67], v2, s[8:11], s45 offen sc1
  s_add_u32 s45, s45, 4096
  buffer_store_dwordx4 v[68:71], v2, s[8:11], s45 offen sc1
  s_add_u32 s45, s45, 4096
  buffer_store_dwordx4 v[72:75], v220, s[8:11], s45 offen sc1
  s_waitcnt vmcnt(0)
  s_barrier
  s_cmp_lg_u32 s18, 0
  s_cbranch_scc1 ARR_s1
  v_mov_b32 v6, 0
  v_mov_b32 v7, 1
  s_mov_b64 exec, 1
  buffer_atomic_add v7, v6, s[8:11], s53 offen sc1
  s_mov_b64 exec, -1
ARR_s1:
  s_nop 0
  s_add_u32 s52, s52, 8
  v_mov_b32 v253, 0
  s_cmp_lg_u32 s18, 0
  s_cbranch_scc1 PL0_s1
  buffer_load_dword v254, v253, s[8:11], s53 offen sc1
PL0_s1:
  s_mul_i32 s21, s17, 102400
  s_lshl_b32 s22, s18, 12
  s_add_u32 s21, s21, s22
  s_add_u32 s21, s21, 0x1e5000
  s_add_u32 s22, s22, 86016
  s_mov_b32 m0, s22
  s_nop 0
  buffer_load_dwordx4 v2, s[8:11], s21 offen offset:0  lds
  buffer_load_dwordx4 v2, s[8:11], s21 offen offset:1024  lds
  buffer_load_dwordx4 v2, s[8:11], s21 offen offset:2048  lds
  buffer_load_dwordx4 v2, s[8:11], s21 offen offset:3072  lds
  v_lshlrev_b32 v144, 16, v240
  v_and_b32 v145, 0xffff0000, v240
  v_lshlrev_b32 v146, 16, v241
  v_and_b32 v147, 0xffff0000, v241
  v_lshlrev_b32 v148, 16, v242
  v_and_b32 v149, 0xffff0000, v242
  v_lshlrev_b32 v150, 16, v243
  v_and_b32 v151, 0xffff0000, v243
  v_lshlrev_b32 v152, 16, v244
  v_and_b32 v153, 0xffff0000, v244
  v_lshlrev_b32 v154, 16, v245
  v_and_b32 v155, 0xffff0000, v245
  v_lshlrev_b32 v156, 16, v246
  v_and_b32 v157, 0xffff0000, v246
  v_lshlrev_b32 v158, 16, v247
  v_and_b32 v159, 0xffff0000, v247
  v_lshlrev_b32 v160, 16, v248
  v_and_b32 v161, 0xffff0000, v248
  v_lshlrev_b32 v162, 16, v249
  v_and_b32 v163, 0xffff0000, v249
  s_cmp_lg_u32 s18, 0
  s_cbranch_scc1 POLLE_s1
  s_waitcnt vmcnt(4)
  s_mov_b32 s23, 0
  v_cmp_le_u32 vcc, s52, v254
  s_nop 3
  s_cmp_eq_u64 vcc, exec
  s_cbranch_scc1 POLLD_s1
POLL_s1:
  buffer_load_dword v254, v253, s[8:11], s53 offen sc1
  s_waitcnt vmcnt(0)
  s_add_u32 s23, s23, 1
  v_cmp_le_u32 vcc, s52, v254
  s_nop 3
  s_cmp_eq_u64 vcc, exec
  s_cbranch_scc1 POLLD_s1
  s_cmp_lt_u32 s23, 400000
  s_cbranch_scc1 POLL_s1
POLLD_s1:
POLLE_s1:
  s_barrier
  s_waitcnt vmcnt(0)
  s_barrier
  s_and_b32 s21, s18, 1
  s_lshr_b32 s22, s18, 1
  s_lshl_b32 s21, s21, 1
  s_add_u32 s28, s21, s22
  s_xor_b32 s23, s28, 1
  s_lshl_b32 s24, s28, 8
  v_add_u32 v52, s24, v3
  s_lshl_b32 s23, s23, 8
  v_add_u32 v53, s23, v3
  s_mul_i32 s22, s22, 40960
  s_add_u32 s26, s43, s22
  s_add_u32 s26, s26, 0x1832000
  buffer_load_dwordx4 v[64:67], v52, s[8:11], s26 offen sc1
  buffer_load_dwordx4 v[68:71], v53, s[8:11], s26 offen sc1
  s_add_u32 s26, s26, 4096
  buffer_load_dwordx4 v[72:75], v52, s[8:11], s26 offen sc1
  buffer_load_dwordx4 v[76:79], v53, s[8:11], s26 offen sc1
  s_add_u32 s26, s26, 4096
  buffer_load_dwordx4 v[80:83], v52, s[8:11], s26 offen sc1
  buffer_load_dwordx4 v[84:87], v53, s[8:11], s26 offen sc1
  s_add_u32 s26, s26, 4096
  buffer_load_dwordx4 v[88:91], v52, s[8:11], s26 offen sc1
  buffer_load_dwordx4 v[92:95], v53, s[8:11], s26 offen sc1
  s_add_u32 s26, s26, 4096
  buffer_load_dwordx4 v[96:99], v52, s[8:11], s26 offen sc1
  buffer_load_dwordx4 v[100:103], v53, s[8:11], s26 offen sc1
  s_add_u32 s26, s26, 4096
  s_mul_i32 s21, s17, 10240
  s_add_u32 s21, s21, s24
  s_add_u32 s27, s43, s21
  s_add_u32 s29, s27, 0x1ab2000
  v_lshrrev_b32 v6, 4, v1
  v_mul_u32_u24 v6, 1280, v6
  v_and_b32 v7, 15, v1
  v_lshl_add_u32 v54, v7, 4, v6
  s_lshr_b32 s22, s18, 1
  s_mul_i32 s22, s22, 51200
  v_add_u32 v54, s22, v54
  v_add_u32 v54, 0, v54
  s_mul_i32 s21, s18, 5120
  v_add_u32 v55, s21, v2
  v_add_u32 v55, 110592, v55
  s_xor_b32 s21, s18, 2
  s_mul_i32 s21, s21, 5120
  v_add_u32 v56, s21, v2
  v_add_u32 v56, 110592, v56
  s_lshl_b32 s30, s16, 12
  s_add_u32 s30, s30, s20
  s_lshl_b32 s21, s17, 9
  s_add_u32 s30, s30, s21
  s_lshl_b32 s21, s28, 7
  s_add_u32 s30, s30, s21
  s_add_u32 s30, s30, 0x1d32000
  v_lshlrev_b32 v6, 3, v1
  v_cmp_gt_u32 vcc, 16, v1
  v_mov_b32 v7, 0x40000000
  s_nop 0
  v_cndmask_b32 v28, v7, v6, vcc
  ds_read_b128 v[184:187], v54 offset:0
  ds_read_b128 v[188:191], v54 offset:256
  ds_read_b128 v[192:195], v54 offset:512
  ds_read_b128 v[196:199], v54 offset:768
  ds_read_b128 v[200:203], v54 offset:1024
  s_waitcnt vmcnt(8) lgkmcnt(0)
  v_mfma_f32_16x16x32_bf16 v[144:147], v[184:187], v[64:67], v[144:147]
  ds_read_b128 v[204:207], v54 offset:5120
  v_mfma_f32_16x16x32_bf16 v[164:167], v[184:187], v[68:71], 0
  ds_read_b128 v[208:211], v54 offset:5376
  v_mfma_f32_16x16x32_bf16 v[148:151], v[188:191], v[64:67], v[148:151]
  ds_read_b128 v[212:215], v54 offset:5632
  v_mfma_f32_16x16x32_bf16 v[168:171], v[188:191], v[68:71], 0
  ds_read_b128 v[216:219], v54 offset:5888
  v_mfma_f32_16x16x32_bf16 v[152:155], v[192:195], v[64:67], v[152:155]
  ds_read_b128 v[220:223], v54 offset:6144
  v_mfma_f32_16x16x32_bf16 v[172:175], v[192:195], v[68:71], 0
  buffer_load_dwordx4 v[104:107], v52, s[8:11], s26 offen sc1
  v_mfma_f32_16x16x32_bf16 v[156:159], v[196:199], v[64:67], v[156:159]
  v_mfma_f32_16x16x32_bf16 v[176:179], v[196:199], v[68:71], 0
  buffer_load_dwordx4 v[108:111], v53, s[8:11], s26 offen sc1
  s_add_u32 s26, s26, 4096
  v_mfma_f32_16x16x32_bf16 v[160:163], v[200:203], v[64:67], v[160:163]
  v_mfma_f32_16x16x32_bf16 v[180:183], v[200:203], v[68:71], 0
  s_waitcnt vmcnt(8) lgkmcnt(0)
  v_mfma_f32_16x16x32_bf16 v[144:147], v[204:207], v[72:75], v[144:147]
  ds_read_b128 v[184:187], v54 offset:10240
  v_mfma_f32_16x16x32_bf16 v[164:167], v[204:207], v[76:79], v[164:167]
  ds_read_b128 v[188:191], v54 offset:10496
  v_mfma_f32_16x16x32_bf16 v[148:151], v[208:211], v[72:75], v[148:151]
  ds_read_b128 v[192:195], v54 offset:10752
  v_mfma_f32_16x16x32_bf16 v[168:171], v[208:211], v[76:79], v[168:171]
  ds_read_b128 v[196:199], v54 offset:11008
  v_mfma_f32_16x16x32_bf16 v[152:155], v[212:215], v[72:75], v[152:155]
  ds_read_b128 v[200:203], v54 offset:11264
  v_mfma_f32_16x16x32_bf16 v[172:175], v[212:215], v[76:79], v[172:175]
  buffer_load_dwordx4 v[112:115], v52, s[8:11], s26 offen sc1
  v_mfma_f32_16x16x32_bf16 v[156:159], v[216:219], v[72:75], v[156:159]
  v_mfma_f32_16x16x32_bf16 v[176:179], v[216:219], v[76:79], v[176:179]
  buffer_load_dwordx4 v[116:119], v53, s[8:11], s26 offen sc1
  s_add_u32 s26, s26, 4096
  v_mfma_f32_16x16x32_bf16 v[160:163], v[220:223], v[72:75], v[160:163]
  v_mfma_f32_16x16x32_bf16 v[180:183], v[220:223], v[76:79], v[180:183]
  s_waitcnt vmcnt(8) lgkmcnt(0)
  v_mfma_f32_16x16x32_bf16 v[144:147], v[184:187], v[80:83], v[144:147]
  ds_read_b128 v[204:207], v54 offset:15360
  v_mfma_f32_16x16x32_bf16 v[164:167], v[184:187], v[84:87], v[164:167]
  ds_read_b128 v[208:211], v54 offset:15616
  v_mfma_f32_16x16x32_bf16 v[148:151], v[188:191], v[80:83], v[148:151]
  ds_read_b128 v[212:215], v54 offset:15872
  v_mfma_f32_16x16x32_bf16 v[168:171], v[188:191], v[84:87], v[168:171]
  ds_read_b128 v[216:219], v54 offset:16128
  v_mfma_f32_16x16x32_bf16 v[152:155], v[192:195], v[80:83], v[152:155]
  ds_read_b128 v[220:223], v54 offset:16384
  v_mfma_f32_16x16x32_bf16 v[172:175], v[192:195], v[84:87], v[172:175]
  buffer_load_dwordx4 v[120:123], v52, s[8:11], s26 offen sc1
  v_mfma_f32_16x16x32_bf16 v[156:159], v[196:199], v[80:83], v[156:159]
  v_mfma_f32_16x16x32_bf16 v[176:179], v[196:199], v[84:87], v[176:179]
  buffer_load_dwordx4 v[124:127], v53, s[8:11], s26 offen sc1
  s_add_u32 s26, s26, 4096
  v_mfma_f32_16x16x32_bf16 v[160:163], v[200:203], v[80:83], v[160:163]
  v_mfma_f32_16x16x32_bf16 v[180:183], v[200:203], v[84:87], v[180:183]
  s_waitcnt vmcnt(8) lgkmcnt(0)
  v_mfma_f32_16x16x32_bf16 v[144:147], v[204:207], v[88:91], v[144:147]
  ds_read_b128 v[184:187], v54 offset:20480
  v_mfma_f32_16x16x32_bf16 v[164:167], v[204:207], v[92:95], v[164:167]
  ds_read_b128 v[188:191], v54 offset:20736
  v_mfma_f32_16x16x32_bf16 v[148:151], v[208:211], v[88:91], v[148:151]
  ds_read_b128 v[192:195], v54 offset:20992
  v_mfma_f32_16x16x32_bf16 v[168:171], v[208:211], v[92:95], v[168:171]
  ds_read_b128 v[196:199], v54 offset:21248
  v_mfma_f32_16x16x32_bf16 v[152:155], v[212:215], v[88:91], v[152:155]
  ds_read_b128 v[200:203], v54 offset:21504
  v_mfma_f32_16x16x32_bf16 v[172:175], v[212:215], v[92:95], v[172:175]
  buffer_load_dwordx4 v[128:131], v52, s[8:11], s26 offen sc1
  v_mfma_f32_16x16x32_bf16 v[156:159], v[216:219], v[88:91], v[156:159]
  v_mfma_f32_16x16x32_bf16 v[176:179], v[216:219], v[92:95], v[176:179]
  buffer_load_dwordx4 v[132:135], v53, s[8:11], s26 offen sc1
  s_add_u32 s26, s26, 4096
  v_mfma_f32_16x16x32_bf16 v[160:163], v[220:223], v[88:91], v[160:163]
  v_mfma_f32_16x16x32_bf16 v[180:183], v[220:223], v[92:95], v[180:183]
  s_waitcnt vmcnt(8) lgkmcnt(0)
  v_mfma_f32_16x16x32_bf16 v[144:147], v[184:187], v[96:99], v[144:147]
  ds_read_b128 v[204:207], v54 offset:25600
  v_mfma_f32_16x16x32_bf16 v[164:167], v[184:187], v[100:103], v[164:167]
  ds_read_b128 v[208:211], v54 offset:25856
  v_mfma_f32_16x16x32_bf16 v[148:151], v[188:191], v[96:99], v[148:151]
  ds_read_b128 v[212:215], v54 offset:26112
  v_mfma_f32_16x16x32_bf16 v[168:171], v[188:191], v[100:103], v[168:171]
  ds_read_b128 v[216:219], v54 offset:26368
  v_mfma_f32_16x16x32_bf16 v[152:155], v[192:195], v[96:99], v[152:155]
  ds_read_b128 v[220:223], v54 offset:26624
  v_mfma_f32_16x16x32_bf16 v[172:175], v[192:195], v[100:103], v[172:175]
  buffer_load_dwordx4 v[136:139], v52, s[8:11], s26 offen sc1
  v_mfma_f32_16x16x32_bf16 v[156:159], v[196:199], v[96:99], v[156:159]
  v_mfma_f32_16x16x32_bf16 v[176:179], v[196:199], v[100:103], v[176:179]
  buffer_load_dwordx4 v[140:143], v53, s[8:11], s26 offen sc1
  s_add_u32 s26, s26, 4096
  v_mfma_f32_16x16x32_bf16 v[160:163], v[200:203], v[96:99], v[160:163]
  v_mfma_f32_16x16x32_bf16 v[180:183], v[200:203], v[100:103], v[180:183]
  s_waitcnt vmcnt(8) lgkmcnt(0)
  v_mfma_f32_16x16x32_bf16 v[144:147], v[204:207], v[104:107], v[144:147]
  ds_read_b128 v[184:187], v54 offset:30720
  v_mfma_f32_16x16x32_bf16 v[164:167], v[204:207], v[108:111], v[164:167]
  ds_read_b128 v[188:191], v54 offset:30976
  v_mfma_f32_16x16x32_bf16 v[148:151], v[208:211], v[104:107], v[148:151]
  ds_read_b128 v[192:195], v54 offset:31232
  v_mfma_f32_16x16x32_bf16 v[168:171], v[208:211], v[108:111], v[168:171]
  ds_read_b128 v[196:199], v54 offset:31488
  v_mfma_f32_16x16x32_bf16 v[152:155], v[212:215], v[104:107], v[152:155]
  ds_read_b128 v[200:203], v54 offset:31744
  v_mfma_f32_16x16x32_bf16 v[172:175], v[212:215], v[108:111], v[172:175]
  s_add_u32 s47, s41, 32768
  s_add_u32 s58, s4, s47
  s_addc_u32 s59, s5, 0
  global_load_dwordx4 a[0:3], v2, s[58:59] offset:0
  v_mfma_f32_16x16x32_bf16 v[156:159], v[216:219], v[104:107], v[156:159]
  v_mfma_f32_16x16x32_bf16 v[176:179], v[216:219], v[108:111], v[176:179]
  global_load_dwordx4 a[4:7], v2, s[58:59] offset:1024
  v_mfma_f32_16x16x32_bf16 v[160:163], v[220:223], v[104:107], v[160:163]
  v_mfma_f32_16x16x32_bf16 v[180:183], v[220:223], v[108:111], v[180:183]
  global_load_dwordx4 a[8:11], v2, s[58:59] offset:2048
  s_waitcnt vmcnt(9) lgkmcnt(0)
  v_mfma_f32_16x16x32_bf16 v[144:147], v[184:187], v[112:115], v[144:147]
  ds_read_b128 v[204:207], v54 offset:35840
  v_mfma_f32_16x16x32_bf16 v[164:167], v[184:187], v[116:119], v[164:167]
  ds_read_b128 v[208:211], v54 offset:36096
  v_mfma_f32_16x16x32_bf16 v[148:151], v[188:191], v[112:115], v[148:151]
  ds_read_b128 v[212:215], v54 offset:36352
  v_mfma_f32_16x16x32_bf16 v[168:171], v[188:191], v[116:119], v[168:171]
  ds_read_b128 v[216:219], v54 offset:36608
  v_mfma_f32_16x16x32_bf16 v[152:155], v[192:195], v[112:115], v[152:155]
  ds_read_b128 v[220:223], v54 offset:36864
  v_mfma_f32_16x16x32_bf16 v[172:175], v[192:195], v[116:119], v[172:175]
  global_load_dwordx4 a[12:15], v2, s[58:59] offset:3072
  v_mfma_f32_16x16x32_bf16 v[156:159], v[196:199], v[112:115], v[156:159]
  v_mfma_f32_16x16x32_bf16 v[176:179], v[196:199], v[116:119], v[176:179]
  s_add_u32 s58, s58, 4096
  s_addc_u32 s59, s59, 0
  global_load_dwordx4 a[16:19], v2, s[58:59] offset:0
  v_mfma_f32_16x16x32_bf16 v[160:163], v[200:203], v[112:115], v[160:163]
  v_mfma_f32_16x16x32_bf16 v[180:183], v[200:203], v[116:119], v[180:183]
  global_load_dwordx4 a[20:23], v2, s[58:59] offset:1024
  s_waitcnt vmcnt(10) lgkmcnt(0)
  v_mfma_f32_16x16x32_bf16 v[144:147], v[204:207], v[120:123], v[144:147]
  ds_read_b128 v[184:187], v54 offset:40960
  v_mfma_f32_16x16x32_bf16 v[164:167], v[204:207], v[124:127], v[164:167]
  ds_read_b128 v[188:191], v54 offset:41216
  v_mfma_f32_16x16x32_bf16 v[148:151], v[208:211], v[120:123], v[148:151]
  ds_read_b128 v[192:195], v54 offset:41472
  v_mfma_f32_16x16x32_bf16 v[168:171], v[208:211], v[124:127], v[168:171]
  ds_read_b128 v[196:199], v54 offset:41728
  v_mfma_f32_16x16x32_bf16 v[152:155], v[212:215], v[120:123], v[152:155]
  ds_read_b128 v[200:203], v54 offset:41984
  v_mfma_f32_16x16x32_bf16 v[172:175], v[212:215], v[124:127], v[172:175]
  global_load_dwordx4 a[24:27], v2, s[58:59] offset:2048
  v_mfma_f32_16x16x32_bf16 v[156:159], v[216:219], v[120:123], v[156:159]
  v_mfma_f32_16x16x32_bf16 v[176:179], v[216:219], v[124:127], v[176:179]
  global_load_dwordx4 a[28:31], v2, s[58:59] offset:3072
  v_mfma_f32_16x16x32_bf16 v[160:163], v[220:223], v[120:123], v[160:163]
  v_mfma_f32_16x16x32_bf16 v[180:183], v[220:223], v[124:127], v[180:183]
  s_waitcnt vmcnt(10) lgkmcnt(0)
  v_mfma_f32_16x16x32_bf16 v[144:147], v[184:187], v[128:131], v[144:147]
  ds_read_b128 v[204:207], v54 offset:46080
  v_mfma_f32_16x16x32_bf16 v[164:167], v[184:187], v[132:135], v[164:167]
  ds_read_b128 v[208:211], v54 offset:46336
  v_mfma_f32_16x16x32_bf16 v[148:151], v[188:191], v[128:131], v[148:151]
  ds_read_b128 v[212:215], v54 offset:46592
  v_mfma_f32_16x16x32_bf16 v[168:171], v[188:191], v[132:135], v[168:171]
  ds_read_b128 v[216:219], v54 offset:46848
  v_mfma_f32_16x16x32_bf16 v[152:155], v[192:195], v[128:131], v[152:155]
  ds_read_b128 v[220:223], v54 offset:47104
  v_mfma_f32_16x16x32_bf16 v[172:175], v[192:195], v[132:135], v[172:175]
  s_add_u32 s47, s41, 57344
  s_add_u32 s58, s4, s47
  s_addc_u32 s59, s5, 0
  global_load_dwordx4 a[96:99], v2, s[58:59] offset:0
  v_mfma_f32_16x16x32_bf16 v[156:159], v[196:199], v[128:131], v[156:159]
  v_mfma_f32_16x16x32_bf16 v[176:179], v[196:199], v[132:135], v[176:179]
  global_load_dwordx4 a[100:103], v2, s[58:59] offset:1024
  v_mfma_f32_16x16x32_bf16 v[160:163], v[200:203], v[128:131], v[160:163]
  v_mfma_f32_16x16x32_bf16 v[180:183], v[200:203], v[132:135], v[180:183]
  s_waitcnt vmcnt(10) lgkmcnt(0)
  v_mfma_f32_16x16x32_bf16 v[164:167], v[204:207], v[140:143], v[164:167]
  v_mfma_f32_16x16x32_bf16 v[168:171], v[208:211], v[140:143], v[168:171]
  v_mfma_f32_16x16x32_bf16 v[172:175], v[212:215], v[140:143], v[172:175]
  v_mfma_f32_16x16x32_bf16 v[176:179], v[216:219], v[140:143], v[176:179]
  v_mfma_f32_16x16x32_bf16 v[180:183], v[220:223], v[140:143], v[180:183]
  v_mfma_f32_16x16x32_bf16 v[144:147], v[204:207], v[136:139], v[144:147]
  global_load_dwordx4 a[104:107], v2, s[58:59] offset:2048
  v_mfma_f32_16x16x32_bf16 v[148:151], v[208:211], v[136:139], v[148:151]
  v_mfma_f32_16x16x32_bf16 v[152:155], v[212:215], v[136:139], v[152:155]
  global_load_dwordx4 a[108:111], v2, s[58:59] offset:3072
  ds_write_b128 v55, v[164:167] offset:0
  v_mfma_f32_16x16x32_bf16 v[156:159], v[216:219], v[136:139], v[156:159]
  ds_write_b128 v55, v[168:171] offset:1024
  v_mfma_f32_16x16x32_bf16 v[160:163], v[220:223], v[136:139], v[160:163]
  ds_write_b128 v55, v[172:175] offset:2048
  ds_write_b128 v55, v[176:179] offset:3072
  ds_write_b128 v55, v[180:183] offset:4096
  s_waitcnt lgkmcnt(0)
  s_barrier
  ds_read_b128 v[184:187], v56 offset:0
  ds_read_b128 v[188:191], v56 offset:1024
  ds_read_b128 v[192:195], v56 offset:2048
  ds_read_b128 v[196:199], v56 offset:3072
  ds_read_b128 v[200:203], v56 offset:4096
  s_waitcnt lgkmcnt(4)
  v_pk_add_f32 v[144:145], v[144:145], v[184:185]
  v_pk_add_f32 v[146:147], v[146:147], v[186:187]
  s_waitcnt lgkmcnt(3)
  v_pk_add_f32 v[148:149], v[148:149], v[188:189]
  v_pk_add_f32 v[150:151], v[150:151], v[190:191]
  s_waitcnt lgkmcnt(2)
  v_pk_add_f32 v[152:153], v[152:153], v[192:193]
  v_pk_add_f32 v[154:155], v[154:155], v[194:195]
  s_waitcnt lgkmcnt(1)
  v_pk_add_f32 v[156:157], v[156:157], v[196:197]
  v_pk_add_f32 v[158:159], v[158:159], v[198:199]
  s_waitcnt lgkmcnt(0)
  v_pk_add_f32 v[160:161], v[160:161], v[200:201]
  v_pk_add_f32 v[162:163], v[162:163], v[202:203]
  v_cvt_pk_bf16_f32 v240, v144, v145
  v_cvt_pk_bf16_f32 v241, v146, v147
  buffer_store_dwordx2 v[240:241], v5, s[8:11], s29 offen offset:0 sc1
  v_cvt_pk_bf16_f32 v242, v148, v149
  v_cvt_pk_bf16_f32 v243, v150, v151
  buffer_store_dwordx2 v[242:243], v5, s[8:11], s29 offen offset:2048 sc1
  v_cvt_pk_bf16_f32 v244, v152, v153
  v_cvt_pk_bf16_f32 v245, v154, v155
  s_add_u32 s29, s29, 4096
  buffer_store_dwordx2 v[244:245], v5, s[8:11], s29 offen offset:0 sc1
  v_cvt_pk_bf16_f32 v246, v156, v157
  v_cvt_pk_bf16_f32 v247, v158, v159
  buffer_store_dwordx2 v[246:247], v5, s[8:11], s29 offen offset:2048 sc1
  v_cvt_pk_bf16_f32 v248, v160, v161
  v_cvt_pk_bf16_f32 v249, v162, v163
  s_add_u32 s29, s29, 4096
  buffer_store_dwordx2 v[248:249], v5, s[8:11], s29 offen offset:0 sc1
  v_pk_mul_f32 v[24:25], v[144:145], v[144:145]
  v_pk_add_f32 v[22:23], v[144:145], v[146:147]
  v_pk_fma_f32 v[24:25], v[146:147], v[146:147], v[24:25]
  v_pk_add_f32 v[22:23], v[22:23], v[148:149]
  v_pk_fma_f32 v[24:25], v[148:149], v[148:149], v[24:25]
  v_pk_add_f32 v[22:23], v[22:23], v[150:151]
  v_pk_fma_f32 v[24:25], v[150:151], v[150:151], v[24:25]
  v_pk_add_f32 v[22:23], v[22:23], v[152:153]
  v_pk_fma_f32 v[24:25], v[152:153], v[152:153], v[24:25]
  v_pk_add_f32 v[22:23], v[22:23], v[154:155]
  v_pk_fma_f32 v[24:25], v[154:155], v[154:155], v[24:25]
  v_pk_add_f32 v[22:23], v[22:23], v[156:157]
  v_pk_fma_f32 v[24:25], v[156:157], v[156:157], v[24:25]
  v_pk_add_f32 v[22:23], v[22:23], v[158:159]
  v_pk_fma_f32 v[24:25], v[158:159], v[158:159], v[24:25]
  v_pk_add_f32 v[22:23], v[22:23], v[160:161]
  v_pk_fma_f32 v[24:25], v[160:161], v[160:161], v[24:25]
  v_pk_add_f32 v[22:23], v[22:23], v[162:163]
  v_pk_fma_f32 v[24:25], v[162:163], v[162:163], v[24:25]
  v_add_f32 v22, v22, v23
  v_add_f32 v23, v24, v25
  v_mov_b32 v6, v22
  v_mov_b32 v7, v23
  s_nop 0
  v_permlane16_swap_b32 v22, v6
  v_permlane16_swap_b32 v23, v7
  v_add_f32 v22, v22, v6
  v_add_f32 v23, v23, v7
  v_mov_b32 v6, v22
  v_mov_b32 v7, v23
  s_nop 0
  v_permlane32_swap_b32 v22, v6
  v_permlane32_swap_b32 v23, v7
  v_add_f32 v22, v22, v6
  v_add_f32 v23, v23, v7
  buffer_store_dwordx2 v[22:23], v28, s[8:11], s30 offen sc1
  s_waitcnt vmcnt(0)
  s_barrier
  s_cmp_lg_u32 s18, 0
  s_cbranch_scc1 ARR_s2
  v_mov_b32 v6, 0
  v_mov_b32 v7, 1
  s_mov_b64 exec, 1
  buffer_atomic_add v7, v6, s[8:11], s53 offen sc1
  s_mov_b64 exec, -1
ARR_s2:
  s_nop 0
  s_add_u32 s52, s52, 8
  v_mov_b32 v253, 0
  s_cmp_lg_u32 s18, 0
  s_cbranch_scc1 PL0_s2
  buffer_load_dword v254, v253, s[8:11], s53 offen sc1
PL0_s2:
  s_cmp_lg_u32 s18, 0
  s_cbranch_scc1 POLLE_s2
  s_waitcnt vmcnt(0)
  s_mov_b32 s23, 0
  v_cmp_le_u32 vcc, s52, v254
  s_nop 3
  s_cmp_eq_u64 vcc, exec
  s_cbranch_scc1 POLLD_s2
POLL_s2:
  buffer_load_dword v254, v253, s[8:11], s53 offen sc1
  s_waitcnt vmcnt(0)
  s_add_u32 s23, s23, 1
  v_cmp_le_u32 vcc, s52, v254
  s_nop 3
  s_cmp_eq_u64 vcc, exec
  s_cbranch_scc1 POLLD_s2
  s_cmp_lt_u32 s23, 400000
  s_cbranch_scc1 POLL_s2
POLLD_s2:
POLLE_s2:
  s_barrier
  s_add_u32 s26, s43, 0x1ab2000
  s_mul_i32 s31, s18, 1024
  s_add_u32 s32, s31, 0
  s_add_u32 s31, s31, s26
  s_mov_b32 m0, s32
  s_nop 0
  buffer_load_dwordx4 v2, s[8:11], s31 offen offset:0 sc1 lds
  s_mul_i32 s31, s18, 3072
  s_add_u32 s32, s31, 4096
  s_add_u32 s31, s31, s26
  s_add_u32 s31, s31, 4096
  s_mov_b32 m0, s32
  s_nop 0
  buffer_load_dwordx4 v2, s[8:11], s31 offen offset:0 sc1 lds
  buffer_load_dwordx4 v2, s[8:11], s31 offen offset:1024 sc1 lds
  buffer_load_dwordx4 v2, s[8:11], s31 offen offset:2048 sc1 lds
  s_mul_i32 s31, s18, 4096
  s_add_u32 s32, s31, 16384
  s_add_u32 s31, s31, s26
  s_add_u32 s31, s31, 16384
  s_mov_b32 m0, s32
  s_nop 0
  buffer_load_dwordx4 v2, s[8:11], s31 offen offset:0 sc1 lds
  buffer_load_dwordx4 v2, s[8:11], s31 offen offset:1024 sc1 lds
  buffer_load_dwordx4 v2, s[8:11], s31 offen offset:2048 sc1 lds
  buffer_load_dwordx4 v2, s[8:11], s31 offen offset:3072 sc1 lds
  s_lshl_b32 s27, s16, 12
  s_add_u32 s27, s27, s20
  s_lshl_b32 s21, s18, 10
  s_add_u32 s27, s27, s21
  s_add_u32 s27, s27, 0x1d32000
  v_lshlrev_b32 v30, 3, v1
  s_lshl_b32 s21, s18, 9
  v_add_u32 v31, s21, v30
  v_add_u32 v31, 83968, v31
  buffer_load_dwordx2 v[22:23], v30, s[8:11], s27 offen offset:0 sc1
  buffer_load_dwordx2 v[24:25], v30, s[8:11], s27 offen offset:512 sc1
  v_add_u32 v38, 0, v3
  v_add_u32 v39, 65536, v3
  v_lshrrev_b32 v6, 4, v1
  v_lshlrev_b32 v6, 4, v6
  s_mul_i32 s21, s18, 192
  v_add_u32 v6, s21, v6
  v_add_u32 v7, 160256, v6
  v_add_u32 v8, 161024, v6
  ds_read_b128 v[144:147], v7 offset:0
  ds_read_b128 v[156:159], v8 offset:0
  ds_read_b128 v[148:151], v7 offset:64
  ds_read_b128 v[160:163], v8 offset:64
  ds_read_b128 v[152:155], v7 offset:128
  ds_read_b128 v[164:167], v8 offset:128
  s_mul_i32 s28, s16, 196608
  s_add_u32 s28, s28, s20
  s_mul_i32 s21, s17, 24576
  s_add_u32 s28, s28, s21
  s_mul_i32 s21, s18, 6144
  s_add_u32 s28, s28, s21
  s_add_u32 s28, s28, 0x1d52000
  s_mov_b32 s50, 0xbdd2d3e8
  v_mov_b32 v192, 0xc0135761
  s_waitcnt vmcnt(9)
  s_barrier
  ds_read_b128 v[112:115], v38 offset:0
  ds_read_b128 v[116:119], v38 offset:256
  ds_read_b128 v[120:123], v38 offset:512
  ds_read_b128 v[124:127], v38 offset:768
  s_waitcnt vmcnt(6)
  s_barrier
  s_waitcnt lgkmcnt(0)
  v_mfma_f32_16x16x32_bf16 v[64:67], a[128:131], v[112:115], 0
  ds_read_b128 v[128:131], v38 offset:4096
  v_mfma_f32_16x16x32_bf16 v[68:71], a[128:131], v[116:119], 0
  ds_read_b128 v[132:135], v38 offset:4352
  v_mfma_f32_16x16x32_bf16 v[72:75], a[128:131], v[120:123], 0
  ds_read_b128 v[136:139], v38 offset:4608
  v_mfma_f32_16x16x32_bf16 v[76:79], a[128:131], v[124:127], 0
  ds_read_b128 v[140:143], v38 offset:4864
  v_mfma_f32_16x16x32_bf16 v[80:83], a[132:135], v[112:115], 0
  v_mfma_f32_16x16x32_bf16 v[84:87], a[132:135], v[116:119], 0
  s_add_u32 s31, s31, 16384
  s_add_u32 s32, s32, 16384
  s_mov_b32 m0, s32
  s_nop 0
  buffer_load_dwordx4 v2, s[8:11], s31 offen offset:0 sc1 lds
  v_mfma_f32_16x16x32_bf16 v[88:91], a[132:135], v[120:123], 0
  v_mfma_f32_16x16x32_bf16 v[92:95], a[132:135], v[124:127], 0
  v_mfma_f32_16x16x32_bf16 v[96:99], a[136:139], v[112:115], 0
  buffer_load_dwordx4 v2, s[8:11], s31 offen offset:1024 sc1 lds
  v_mfma_f32_16x16x32_bf16 v[100:103], a[136:139], v[116:119], 0
  v_mfma_f32_16x16x32_bf16 v[104:107], a[136:139], v[120:123], 0
  v_mfma_f32_16x16x32_bf16 v[108:111], a[136:139], v[124:127], 0
  buffer_load_dwordx4 v2, s[8:11], s31 offen offset:2048 sc1 lds
  s_waitcnt lgkmcnt(0)
  v_mfma_f32_16x16x32_bf16 v[64:67], a[140:143], v[128:131], v[64:67]
  ds_read_b128 v[112:115], v38 offset:8192
  v_mfma_f32_16x16x32_bf16 v[68:71], a[140:143], v[132:135], v[68:71]
  ds_read_b128 v[116:119], v38 offset:8448
  v_mfma_f32_16x16x32_bf16 v[72:75], a[140:143], v[136:139], v[72:75]
  ds_read_b128 v[120:123], v38 offset:8704
  v_mfma_f32_16x16x32_bf16 v[76:79], a[140:143], v[140:143], v[76:79]
  ds_read_b128 v[124:127], v38 offset:8960
  v_mfma_f32_16x16x32_bf16 v[80:83], a[144:147], v[128:131], v[80:83]
  v_mfma_f32_16x16x32_bf16 v[84:87], a[144:147], v[132:135], v[84:87]
  buffer_load_dwordx4 v2, s[8:11], s31 offen offset:3072 sc1 lds
  v_mfma_f32_16x16x32_bf16 v[88:91], a[144:147], v[136:139], v[88:91]
  v_mfma_f32_16x16x32_bf16 v[92:95], a[144:147], v[140:143], v[92:95]
  v_mfma_f32_16x16x32_bf16 v[96:99], a[148:151], v[128:131], v[96:99]
  s_add_u32 s47, s42, 0
  s_add_u32 s58, s4, s47
  s_addc_u32 s59, s5, 0
  global_load_dwordx4 a[128:131], v2, s[58:59] offset:0
  v_mfma_f32_16x16x32_bf16 v[100:103], a[148:151], v[132:135], v[100:103]
  v_mfma_f32_16x16x32_bf16 v[104:107], a[148:151], v[136:139], v[104:107]
  v_mfma_f32_16x16x32_bf16 v[108:111], a[148:151], v[140:143], v[108:111]
  global_load_dwordx4 a[132:135], v2, s[58:59] offset:1024
  s_waitcnt lgkmcnt(0)
  v_mfma_f32_16x16x32_bf16 v[64:67], a[152:155], v[112:115], v[64:67]
  ds_read_b128 v[128:131], v38 offset:12288
  v_mfma_f32_16x16x32_bf16 v[68:71], a[152:155], v[116:119], v[68:71]
  ds_read_b128 v[132:135], v38 offset:12544
  v_mfma_f32_16x16x32_bf16 v[72:75], a[152:155], v[120:123], v[72:75]
  ds_read_b128 v[136:139], v38 offset:12800
  v_mfma_f32_16x16x32_bf16 v[76:79], a[152:155], v[124:127], v[76:79]
  ds_read_b128 v[140:143], v38 offset:13056
  v_mfma_f32_16x16x32_bf16 v[80:83], a[156:159], v[112:115], v[80:83]
  v_mfma_f32_16x16x32_bf16 v[84:87], a[156:159], v[116:119], v[84:87]
  global_load_dwordx4 a[136:139], v2, s[58:59] offset:2048
  v_mfma_f32_16x16x32_bf16 v[88:91], a[156:159], v[120:123], v[88:91]
  v_mfma_f32_16x16x32_bf16 v[92:95], a[156:159], v[124:127], v[92:95]
  v_mfma_f32_16x16x32_bf16 v[96:99], a[160:163], v[112:115], v[96:99]
  global_load_dwordx4 a[140:143], v2, s[58:59] offset:3072
  v_mfma_f32_16x16x32_bf16 v[100:103], a[160:163], v[116:119], v[100:103]
  v_mfma_f32_16x16x32_bf16 v[104:107], a[160:163], v[120:123], v[104:107]
  v_mfma_f32_16x16x32_bf16 v[108:111], a[160:163], v[124:127], v[108:111]
  s_add_u32 s58, s58, 4096
  s_addc_u32 s59, s59, 0
  global_load_dwordx4 a[144:147], v2, s[58:59] offset:0
  s_waitcnt vmcnt(11)
  s_barrier
  s_waitcnt lgkmcnt(0)
  v_mfma_f32_16x16x32_bf16 v[64:67], a[164:167], v[128:131], v[64:67]
  ds_read_b128 v[112:115], v38 offset:16384
  v_mfma_f32_16x16x32_bf16 v[68:71], a[164:167], v[132:135], v[68:71]
  ds_read_b128 v[116:119], v38 offset:16640
  v_mfma_f32_16x16x32_bf16 v[72:75], a[164:167], v[136:139], v[72:75]
  ds_read_b128 v[120:123], v38 offset:16896
  v_mfma_f32_16x16x32_bf16 v[76:79], a[164:167], v[140:143], v[76:79]
  ds_read_b128 v[124:127], v38 offset:17152
  v_mfma_f32_16x16x32_bf16 v[80:83], a[168:171], v[128:131], v[80:83]
  v_mfma_f32_16x16x32_bf16 v[84:87], a[168:171], v[132:135], v[84:87]
  global_load_dwordx4 a[148:151], v2, s[58:59] offset:1024
  v_mfma_f32_16x16x32_bf16 v[88:91], a[168:171], v[136:139], v[88:91]
  v_mfma_f32_16x16x32_bf16 v[92:95], a[168:171], v[140:143], v[92:95]
  v_mfma_f32_16x16x32_bf16 v[96:99], a[172:175], v[128:131], v[96:99]
  global_load_dwordx4 a[152:155], v2, s[58:59] offset:2048
  v_mfma_f32_16x16x32_bf16 v[100:103], a[172:175], v[132:135], v[100:103]
  v_mfma_f32_16x16x32_bf16 v[104:107], a[172:175], v[136:139], v[104:107]
  v_mfma_f32_16x16x32_bf16 v[108:111], a[172:175], v[140:143], v[108:111]
  global_load_dwordx4 a[156:159], v2, s[58:59] offset:3072
  s_waitcnt lgkmcnt(0)
  v_mfma_f32_16x16x32_bf16 v[64:67], a[176:179], v[112:115], v[64:67]
  ds_read_b128 v[128:131], v38 offset:20480
  v_mfma_f32_16x16x32_bf16 v[68:71], a[176:179], v[116:119], v[68:71]
  ds_read_b128 v[132:135], v38 offset:20736
  v_mfma_f32_16x16x32_bf16 v[72:75], a[176:179], v[120:123], v[72:75]
  ds_read_b128 v[136:139], v38 offset:20992
  v_mfma_f32_16x16x32_bf16 v[76:79], a[176:179], v[124:127], v[76:79]
  ds_read_b128 v[140:143], v38 offset:21248
  v_mfma_f32_16x16x32_bf16 v[80:83], a[180:183], v[112:115], v[80:83]
  v_mfma_f32_16x16x32_bf16 v[84:87], a[180:183], v[116:119], v[84:87]
  s_add_u32 s31, s31, 16384
  s_add_u32 s32, s32, 16384
  s_mov_b32 m0, s32
  s_nop 0
  buffer_load_dwordx4 v2, s[8:11], s31 offen offset:0 sc1 lds
  v_mfma_f32_16x16x32_bf16 v[88:91], a[180:183], v[120:123], v[88:91]
  v_mfma_f32_16x16x32_bf16 v[92:95], a[180:183], v[124:127], v[92:95]
  v_mfma_f32_16x16x32_bf16 v[96:99], a[184:187], v[112:115], v[96:99]
  buffer_load_dwordx4 v2, s[8:11], s31 offen offset:1024 sc1 lds
  v_mfma_f32_16x16x32_bf16 v[100:103], a[184:187], v[116:119], v[100:103]
  v_mfma_f32_16x16x32_bf16 v[104:107], a[184:187], v[120:123], v[104:107]
  v_mfma_f32_16x16x32_bf16 v[108:111], a[184:187], v[124:127], v[108:111]
  buffer_load_dwordx4 v2, s[8:11], s31 offen offset:2048 sc1 lds
  s_waitcnt vmcnt(15)
  v_pk_add_f32 v[22:23], v[22:23], v[24:25]
  ds_write_b64 v31, v[22:23]
  v_add_u32 v30, 83968, v30
  s_waitcnt lgkmcnt(1)
  v_mfma_f32_16x16x32_bf16 v[64:67], a[188:191], v[128:131], v[64:67]
  ds_read_b128 v[112:115], v38 offset:24576
  v_mfma_f32_16x16x32_bf16 v[68:71], a[188:191], v[132:135], v[68:71]
  ds_read_b128 v[116:119], v38 offset:24832
  v_mfma_f32_16x16x32_bf16 v[72:75], a[188:191], v[136:139], v[72:75]
  ds_read_b128 v[120:123], v38 offset:25088
  v_mfma_f32_16x16x32_bf16 v[76:79], a[188:191], v[140:143], v[76:79]
  ds_read_b128 v[124:127], v38 offset:25344
  v_mfma_f32_16x16x32_bf16 v[80:83], a[192:195], v[128:131], v[80:83]
  v_mfma_f32_16x16x32_bf16 v[84:87], a[192:195], v[132:135], v[84:87]
  buffer_load_dwordx4 v2, s[8:11], s31 offen offset:3072 sc1 lds
  v_mfma_f32_16x16x32_bf16 v[88:91], a[192:195], v[136:139], v[88:91]
  v_mfma_f32_16x16x32_bf16 v[92:95], a[192:195], v[140:143], v[92:95]
  v_mfma_f32_16x16x32_bf16 v[96:99], a[196:199], v[128:131], v[96:99]
  s_add_u32 s58, s58, 4096
  s_addc_u32 s59, s59, 0
  global_load_dwordx4 a[160:163], v2, s[58:59] offset:0
  v_mfma_f32_16x16x32_bf16 v[100:103], a[196:199], v[132:135], v[100:103]
  v_mfma_f32_16x16x32_bf16 v[104:107], a[196:199], v[136:139], v[104:107]
  v_mfma_f32_16x16x32_bf16 v[108:111], a[196:199], v[140:143], v[108:111]
  global_load_dwordx4 a[164:167], v2, s[58:59] offset:1024
  s_waitcnt lgkmcnt(0)
  v_mfma_f32_16x16x32_bf16 v[64:67], a[200:203], v[112:115], v[64:67]
  ds_read_b128 v[128:131], v38 offset:28672
  v_mfma_f32_16x16x32_bf16 v[68:71], a[200:203], v[116:119], v[68:71]
  ds_read_b128 v[132:135], v38 offset:28928
  v_mfma_f32_16x16x32_bf16 v[72:75], a[200:203], v[120:123], v[72:75]
  ds_read_b128 v[136:139], v38 offset:29184
  v_mfma_f32_16x16x32_bf16 v[76:79], a[200:203], v[124:127], v[76:79]
  ds_read_b128 v[140:143], v38 offset:29440
  v_mfma_f32_16x16x32_bf16 v[80:83], a[204:207], v[112:115], v[80:83]
  v_mfma_f32_16x16x32_bf16 v[84:87], a[204:207], v[116:119], v[84:87]
  global_load_dwordx4 a[168:171], v2, s[58:59] offset:2048
  v_mfma_f32_16x16x32_bf16 v[88:91], a[204:207], v[120:123], v[88:91]
  v_mfma_f32_16x16x32_bf16 v[92:95], a[204:207], v[124:127], v[92:95]
  v_mfma_f32_16x16x32_bf16 v[96:99], a[208:211], v[112:115], v[96:99]
  global_load_dwordx4 a[172:175], v2, s[58:59] offset:3072
  v_mfma_f32_16x16x32_bf16 v[100:103], a[208:211], v[116:119], v[100:103]
  v_mfma_f32_16x16x32_bf16 v[104:107], a[208:211], v[120:123], v[104:107]
  v_mfma_f32_16x16x32_bf16 v[108:111], a[208:211], v[124:127], v[108:111]
  s_add_u32 s58, s58, 4096
  s_addc_u32 s59, s59, 0
  global_load_dwordx4 a[176:179], v2, s[58:59] offset:0
  s_waitcnt vmcnt(17)
  s_barrier
  s_waitcnt lgkmcnt(0)
  v_mfma_f32_16x16x32_bf16 v[64:67], a[212:215], v[128:131], v[64:67]
  ds_read_b128 v[112:115], v38 offset:32768
  v_mfma_f32_16x16x32_bf16 v[68:71], a[212:215], v[132:135], v[68:71]
  ds_read_b128 v[116:119], v38 offset:33024
  v_mfma_f32_16x16x32_bf16 v[72:75], a[212:215], v[136:139], v[72:75]
  ds_read_b128 v[120:123], v38 offset:33280
  v_mfma_f32_16x16x32_bf16 v[76:79], a[212:215], v[140:143], v[76:79]
  ds_read_b128 v[124:127], v38 offset:33536
  v_mfma_f32_16x16x32_bf16 v[80:83], a[216:219], v[128:131], v[80:83]
  v_mfma_f32_16x16x32_bf16 v[84:87], a[216:219], v[132:135], v[84:87]
  global_load_dwordx4 a[180:183], v2, s[58:59] offset:1024
  v_mfma_f32_16x16x32_bf16 v[88:91], a[216:219], v[136:139], v[88:91]
  v_mfma_f32_16x16x32_bf16 v[92:95], a[216:219], v[140:143], v[92:95]
  v_mfma_f32_16x16x32_bf16 v[96:99], a[220:223], v[128:131], v[96:99]
  global_load_dwordx4 a[184:187], v2, s[58:59] offset:2048
  v_mfma_f32_16x16x32_bf16 v[100:103], a[220:223], v[132:135], v[100:103]
  v_mfma_f32_16x16x32_bf16 v[104:107], a[220:223], v[136:139], v[104:107]
  v_mfma_f32_16x16x32_bf16 v[108:111], a[220:223], v[140:143], v[108:111]
  global_load_dwordx4 a[188:191], v2, s[58:59] offset:3072
  s_waitcnt lgkmcnt(0)
  v_mfma_f32_16x16x32_bf16 v[64:67], a[224:227], v[112:115], v[64:67]
  ds_read_b128 v[128:131], v38 offset:36864
  v_mfma_f32_16x16x32_bf16 v[68:71], a[224:227], v[116:119], v[68:71]
  ds_read_b128 v[132:135], v38 offset:37120
  v_mfma_f32_16x16x32_bf16 v[72:75], a[224:227], v[120:123], v[72:75]
  ds_read_b128 v[136:139], v38 offset:37376
  v_mfma_f32_16x16x32_bf16 v[76:79], a[224:227], v[124:127], v[76:79]
  ds_read_b128 v[140:143], v38 offset:37632
  v_mfma_f32_16x16x32_bf16 v[80:83], a[228:231], v[112:115], v[80:83]
  v_mfma_f32_16x16x32_bf16 v[84:87], a[228:231], v[116:119], v[84:87]
  s_add_u32 s31, s31, 16384
  s_add_u32 s32, s32, 16384
  s_mov_b32 m0, s32
  s_nop 0
  buffer_load_dwordx4 v2, s[8:11], s31 offen offset:0 sc1 lds
  v_mfma_f32_16x16x32_bf16 v[88:91], a[228:231], v[120:123], v[88:91]
  v_mfma_f32_16x16x32_bf16 v[92:95], a[228:231], v[124:127], v[92:95]
  ds_read_b64 v[22:23], v30 offset:0
  v_mfma_f32_16x16x32_bf16 v[96:99], a[232:235], v[112:115], v[96:99]
  buffer_load_dwordx4 v2, s[8:11], s31 offen offset:1024 sc1 lds
  v_mfma_f32_16x16x32_bf16 v[100:103], a[232:235], v[116:119], v[100:103]
  v_mfma_f32_16x16x32_bf16 v[104:107], a[232:235], v[120:123], v[104:107]
  ds_read_b64 v[24:25], v30 offset:512
  v_mfma_f32_16x16x32_bf16 v[108:111], a[232:235], v[124:127], v[108:111]
  buffer_load_dwordx4 v2, s[8:11], s31 offen offset:2048 sc1 lds
  s_waitcnt lgkmcnt(2)
  v_mfma_f32_16x16x32_bf16 v[64:67], a[236:239], v[128:131], v[64:67]
  ds_read_b128 v[112:115], v38 offset:40960
  v_mfma_f32_16x16x32_bf16 v[68:71], a[236:239], v[132:135], v[68:71]
  ds_read_b128 v[116:119], v38 offset:41216
  v_mfma_f32_16x16x32_bf16 v[72:75], a[236:239], v[136:139], v[72:75]
  ds_read_b128 v[120:123], v38 offset:41472
  v_mfma_f32_16x16x32_bf16 v[76:79], a[236:239], v[140:143], v[76:79]
  ds_read_b128 v[124:127], v38 offset:41728
  v_mfma_f32_16x16x32_bf16 v[80:83], a[240:243], v[128:131], v[80:83]
  v_mfma_f32_16x16x32_bf16 v[84:87], a[240:243], v[132:135], v[84:87]
  buffer_load_dwordx4 v2, s[8:11], s31 offen offset:3072 sc1 lds
  v_mfma_f32_16x16x32_bf16 v[88:91], a[240:243], v[136:139], v[88:91]
  v_mfma_f32_16x16x32_bf16 v[92:95], a[240:243], v[140:143], v[92:95]
  ds_read_b64 v[26:27], v30 offset:1024
  v_mfma_f32_16x16x32_bf16 v[96:99], a[244:247], v[128:131], v[96:99]
  s_add_u32 s58, s58, 4096
  s_addc_u32 s59, s59, 0
  global_load_dwordx4 a[192:195], v2, s[58:59] offset:0
  v_mfma_f32_16x16x32_bf16 v[100:103], a[244:247], v[132:135], v[100:103]
  v_mfma_f32_16x16x32_bf16 v[104:107], a[244:247], v[136:139], v[104:107]
  ds_read_b64 v[28:29], v30 offset:1536
  v_mfma_f32_16x16x32_bf16 v[108:111], a[244:247], v[140:143], v[108:111]
  global_load_dwordx4 a[196:199], v2, s[58:59] offset:1024
  s_waitcnt lgkmcnt(2)
  v_mfma_f32_16x16x32_bf16 v[64:67], a[248:251], v[112:115], v[64:67]
  ds_read_b128 v[128:131], v38 offset:45056
  v_mfma_f32_16x16x32_bf16 v[68:71], a[248:251], v[116:119], v[68:71]
  ds_read_b128 v[132:135], v38 offset:45312
  v_mfma_f32_16x16x32_bf16 v[72:75], a[248:251], v[120:123], v[72:75]
  ds_read_b128 v[136:139], v38 offset:45568
  v_mfma_f32_16x16x32_bf16 v[76:79], a[248:251], v[124:127], v[76:79]
  ds_read_b128 v[140:143], v38 offset:45824
  v_mfma_f32_16x16x32_bf16 v[80:83], a[252:255], v[112:115], v[80:83]
  v_mfma_f32_16x16x32_bf16 v[84:87], a[252:255], v[116:119], v[84:87]
  global_load_dwordx4 a[200:203], v2, s[58:59] offset:2048
  v_mfma_f32_16x16x32_bf16 v[88:91], a[252:255], v[120:123], v[88:91]
  v_mfma_f32_16x16x32_bf16 v[92:95], a[252:255], v[124:127], v[92:95]
  v_mfma_f32_16x16x32_bf16 v[96:99], a[0:3], v[112:115], v[96:99]
  global_load_dwordx4 a[204:207], v2, s[58:59] offset:3072
  v_mfma_f32_16x16x32_bf16 v[100:103], a[0:3], v[116:119], v[100:103]
  v_mfma_f32_16x16x32_bf16 v[104:107], a[0:3], v[120:123], v[104:107]
  v_mfma_f32_16x16x32_bf16 v[108:111], a[0:3], v[124:127], v[108:111]
  s_add_u32 s58, s58, 4096
  s_addc_u32 s59, s59, 0
  global_load_dwordx4 a[208:211], v2, s[58:59] offset:0
  s_waitcnt vmcnt(17)
  s_barrier
  s_waitcnt lgkmcnt(0)
  v_mfma_f32_16x16x32_bf16 v[64:67], a[4:7], v[128:131], v[64:67]
  ds_read_b128 v[112:115], v38 offset:49152
  v_mfma_f32_16x16x32_bf16 v[68:71], a[4:7], v[132:135], v[68:71]
  ds_read_b128 v[116:119], v38 offset:49408
  v_mfma_f32_16x16x32_bf16 v[72:75], a[4:7], v[136:139], v[72:75]
  ds_read_b128 v[120:123], v38 offset:49664
  v_mfma_f32_16x16x32_bf16 v[76:79], a[4:7], v[140:143], v[76:79]
  ds_read_b128 v[124:127], v38 offset:49920
  v_mfma_f32_16x16x32_bf16 v[80:83], a[8:11], v[128:131], v[80:83]
  v_mfma_f32_16x16x32_bf16 v[84:87], a[8:11], v[132:135], v[84:87]
  global_load_dwordx4 a[212:215], v2, s[58:59] offset:1024
  v_mfma_f32_16x16x32_bf16 v[88:91], a[8:11], v[136:139], v[88:91]
  v_mfma_f32_16x16x32_bf16 v[92:95], a[8:11], v[140:143], v[92:95]
  v_mfma_f32_16x16x32_bf16 v[96:99], a[12:15], v[128:131], v[96:99]
  global_load_dwordx4 a[216:219], v2, s[58:59] offset:2048
  v_mfma_f32_16x16x32_bf16 v[100:103], a[12:15], v[132:135], v[100:103]
  v_mfma_f32_16x16x32_bf16 v[104:107], a[12:15], v[136:139], v[104:107]
  v_mfma_f32_16x16x32_bf16 v[108:111], a[12:15], v[140:143], v[108:111]
  global_load_dwordx4 a[220:223], v2, s[58:59] offset:3072
  s_waitcnt lgkmcnt(0)
  v_mfma_f32_16x16x32_bf16 v[64:67], a[16:19], v[112:115], v[64:67]
  ds_read_b128 v[128:131], v38 offset:53248
  v_mfma_f32_16x16x32_bf16 v[68:71], a[16:19], v[116:119], v[68:71]
  ds_read_b128 v[132:135], v38 offset:53504
  v_mfma_f32_16x16x32_bf16 v[72:75], a[16:19], v[120:123], v[72:75]
  ds_read_b128 v[136:139], v38 offset:53760
  v_mfma_f32_16x16x32_bf16 v[76:79], a[16:19], v[124:127], v[76:79]
  ds_read_b128 v[140:143], v38 offset:54016
  v_mfma_f32_16x16x32_bf16 v[80:83], a[20:23], v[112:115], v[80:83]
  v_mfma_f32_16x16x32_bf16 v[84:87], a[20:23], v[116:119], v[84:87]
  s_add_u32 s58, s58, 4096
  s_addc_u32 s59, s59, 0
  global_load_dwordx4 a[224:227], v2, s[58:59] offset:0
  v_mfma_f32_16x16x32_bf16 v[88:91], a[20:23], v[120:123], v[88:91]
  v_mfma_f32_16x16x32_bf16 v[92:95], a[20:23], v[124:127], v[92:95]
  v_pk_add_f32 v[22:23], v[22:23], v[24:25]
  v_mfma_f32_16x16x32_bf16 v[96:99], a[24:27], v[112:115], v[96:99]
  global_load_dwordx4 a[228:231], v2, s[58:59] offset:1024
  v_mfma_f32_16x16x32_bf16 v[100:103], a[24:27], v[116:119], v[100:103]
  v_pk_add_f32 v[26:27], v[26:27], v[28:29]
  v_pk_add_f32 v[22:23], v[22:23], v[26:27]
  v_mfma_f32_16x16x32_bf16 v[104:107], a[24:27], v[120:123], v[104:107]
  v_mul_f32 v40, 0x3acccccd, v22
  v_mfma_f32_16x16x32_bf16 v[108:111], a[24:27], v[124:127], v[108:111]
  global_load_dwordx4 a[232:235], v2, s[58:59] offset:2048
  s_waitcnt lgkmcnt(0)
  v_mfma_f32_16x16x32_bf16 v[64:67], a[28:31], v[128:131], v[64:67]
  ds_read_b128 v[112:115], v38 offset:57344
  v_mfma_f32_16x16x32_bf16 v[68:71], a[28:31], v[132:135], v[68:71]
  ds_read_b128 v[116:119], v38 offset:57600
  v_mfma_f32_16x16x32_bf16 v[72:75], a[28:31], v[136:139], v[72:75]
  ds_read_b128 v[120:123], v38 offset:57856
  v_mfma_f32_16x16x32_bf16 v[76:79], a[28:31], v[140:143], v[76:79]
  ds_read_b128 v[124:127], v38 offset:58112
  v_mfma_f32_16x16x32_bf16 v[80:83], a[32:35], v[128:131], v[80:83]
  v_mul_f32 v41, 0x3acccccd, v23
  v_mfma_f32_16x16x32_bf16 v[84:87], a[32:35], v[132:135], v[84:87]
  global_load_dwordx4 a[236:239], v2, s[58:59] offset:3072
  v_mfma_f32_16x16x32_bf16 v[88:91], a[32:35], v[136:139], v[88:91]
  v_fma_f32 v41, -v40, v40, v41
  v_mfma_f32_16x16x32_bf16 v[92:95], a[32:35], v[140:143], v[92:95]
  v_max_f32 v41, 0, v41
  v_add_f32 v41, 0x3727c5ac, v41
  v_mfma_f32_16x16x32_bf16 v[96:99], a[36:39], v[128:131], v[96:99]
  s_add_u32 s58, s58, 4096
  s_addc_u32 s59, s59, 0
  global_load_dwordx4 a[240:243], v2, s[58:59] offset:0
  v_mfma_f32_16x16x32_bf16 v[100:103], a[36:39], v[132:135], v[100:103]
  v_mfma_f32_16x16x32_bf16 v[104:107], a[36:39], v[136:139], v[104:107]
  v_rsq_f32 v41, v41
  v_mfma_f32_16x16x32_bf16 v[108:111], a[36:39], v[140:143], v[108:111]
  global_load_dwordx4 a[244:247], v2, s[58:59] offset:1024
  s_waitcnt lgkmcnt(0)
  v_mfma_f32_16x16x32_bf16 v[64:67], a[40:43], v[112:115], v[64:67]
  ds_read_b128 v[128:131], v38 offset:61440
  v_mfma_f32_16x16x32_bf16 v[68:71], a[40:43], v[116:119], v[68:71]
  ds_read_b128 v[132:135], v38 offset:61696
  v_mfma_f32_16x16x32_bf16 v[72:75], a[40:43], v[120:123], v[72:75]
  ds_read_b128 v[136:139], v38 offset:61952
  v_mfma_f32_16x16x32_bf16 v[76:79], a[40:43], v[124:127], v[76:79]
  ds_read_b128 v[140:143], v38 offset:62208
  v_mfma_f32_16x16x32_bf16 v[80:83], a[44:47], v[112:115], v[80:83]
  v_mul_f32 v40, v40, v41
  v_mfma_f32_16x16x32_bf16 v[84:87], a[44:47], v[116:119], v[84:87]
  global_load_dwordx4 a[248:251], v2, s[58:59] offset:2048
  v_mfma_f32_16x16x32_bf16 v[88:91], a[44:47], v[120:123], v[88:91]
  v_mov_b32 v176, v40
  v_mov_b32 v180, v40
  v_mfma_f32_16x16x32_bf16 v[92:95], a[44:47], v[124:127], v[92:95]
  s_nop 0
  v_permlane32_swap_b32 v176, v180
  v_mfma_f32_16x16x32_bf16 v[96:99], a[48:51], v[112:115], v[96:99]
  global_load_dwordx4 a[252:255], v2, s[58:59] offset:3072
  v_mfma_f32_16x16x32_bf16 v[100:103], a[48:51], v[116:119], v[100:103]
  v_mov_b32 v178, v176
  v_mfma_f32_16x16x32_bf16 v[104:107], a[48:51], v[120:123], v[104:107]
  v_mov_b32 v182, v180
  v_mfma_f32_16x16x32_bf16 v[108:111], a[48:51], v[124:127], v[108:111]
  s_add_u32 s58, s58, 4096
  s_addc_u32 s59, s59, 0
  global_load_dwordx4 a[0:3], v2, s[58:59] offset:0
  s_waitcnt vmcnt(17)
  s_barrier
  s_waitcnt lgkmcnt(0)
  v_mfma_f32_16x16x32_bf16 v[64:67], a[52:55], v[128:131], v[64:67]
  ds_read_b128 v[112:115], v39 offset:0
  v_mfma_f32_16x16x32_bf16 v[68:71], a[52:55], v[132:135], v[68:71]
  ds_read_b128 v[116:119], v39 offset:256
  v_mfma_f32_16x16x32_bf16 v[72:75], a[52:55], v[136:139], v[72:75]
  ds_read_b128 v[120:123], v39 offset:512
  v_mfma_f32_16x16x32_bf16 v[76:79], a[52:55], v[140:143], v[76:79]
  ds_read_b128 v[124:127], v39 offset:768
  v_mfma_f32_16x16x32_bf16 v[80:83], a[56:59], v[128:131], v[80:83]
  v_permlane16_swap_b32 v176, v178
  v_permlane16_swap_b32 v180, v182
  v_mfma_f32_16x16x32_bf16 v[84:87], a[56:59], v[132:135], v[84:87]
  global_load_dwordx4 a[4:7], v2, s[58:59] offset:1024
  v_mfma_f32_16x16x32_bf16 v[88:91], a[56:59], v[136:139], v[88:91]
  v_mov_b32 v184, v41
  v_mfma_f32_16x16x32_bf16 v[92:95], a[56:59], v[140:143], v[92:95]
  v_mov_b32 v188, v41
  v_mfma_f32_16x16x32_bf16 v[96:99], a[60:63], v[128:131], v[96:99]
  global_load_dwordx4 a[8:11], v2, s[58:59] offset:2048
  v_mfma_f32_16x16x32_bf16 v[100:103], a[60:63], v[132:135], v[100:103]
  v_permlane32_swap_b32 v184, v188
  v_mfma_f32_16x16x32_bf16 v[104:107], a[60:63], v[136:139], v[104:107]
  v_mov_b32 v186, v184
  v_mov_b32 v190, v188
  v_mfma_f32_16x16x32_bf16 v[108:111], a[60:63], v[140:143], v[108:111]
  global_load_dwordx4 a[12:15], v2, s[58:59] offset:3072
  s_waitcnt lgkmcnt(0)
  v_mfma_f32_16x16x32_bf16 v[64:67], a[64:67], v[112:115], v[64:67]
  ds_read_b128 v[128:131], v39 offset:4096
  v_mfma_f32_16x16x32_bf16 v[68:71], a[64:67], v[116:119], v[68:71]
  ds_read_b128 v[132:135], v39 offset:4352
  v_mfma_f32_16x16x32_bf16 v[72:75], a[64:67], v[120:123], v[72:75]
  ds_read_b128 v[136:139], v39 offset:4608
  v_mfma_f32_16x16x32_bf16 v[76:79], a[64:67], v[124:127], v[76:79]
  ds_read_b128 v[140:143], v39 offset:4864
  v_mfma_f32_16x16x32_bf16 v[80:83], a[68:71], v[112:115], v[80:83]
  v_permlane16_swap_b32 v184, v186
  v_mfma_f32_16x16x32_bf16 v[84:87], a[68:71], v[116:119], v[84:87]
  s_add_u32 s58, s58, 4096
  s_addc_u32 s59, s59, 0
  global_load_dwordx4 a[16:19], v2, s[58:59] offset:0
  v_mfma_f32_16x16x32_bf16 v[88:91], a[68:71], v[120:123], v[88:91]
  v_permlane16_swap_b32 v188, v190
  v_mfma_f32_16x16x32_bf16 v[92:95], a[68:71], v[124:127], v[92:95]
  v_mfma_f32_16x16x32_bf16 v[96:99], a[72:75], v[112:115], v[96:99]
  global_load_dwordx4 a[20:23], v2, s[58:59] offset:1024
  v_mfma_f32_16x16x32_bf16 v[100:103], a[72:75], v[116:119], v[100:103]
  v_mfma_f32_16x16x32_bf16 v[104:107], a[72:75], v[120:123], v[104:107]
  v_mfma_f32_16x16x32_bf16 v[108:111], a[72:75], v[124:127], v[108:111]
  global_load_dwordx4 a[24:27], v2, s[58:59] offset:2048
  s_waitcnt lgkmcnt(0)
  v_mfma_f32_16x16x32_bf16 v[64:67], a[76:79], v[128:131], v[64:67]
  ds_read_b128 v[112:115], v39 offset:8192
  v_mfma_f32_16x16x32_bf16 v[68:71], a[76:79], v[132:135], v[68:71]
  ds_read_b128 v[116:119], v39 offset:8448
  v_mfma_f32_16x16x32_bf16 v[72:75], a[76:79], v[136:139], v[72:75]
  ds_read_b128 v[120:123], v39 offset:8704
  v_mfma_f32_16x16x32_bf16 v[76:79], a[76:79], v[140:143], v[76:79]
  ds_read_b128 v[124:127], v39 offset:8960
  v_mfma_f32_16x16x32_bf16 v[80:83], a[80:83], v[128:131], v[80:83]
  v_mfma_f32_16x16x32_bf16 v[84:87], a[80:83], v[132:135], v[84:87]
  global_load_dwordx4 a[28:31], v2, s[58:59] offset:3072
  v_mfma_f32_16x16x32_bf16 v[88:91], a[80:83], v[136:139], v[88:91]
  v_mfma_f32_16x16x32_bf16 v[92:95], a[80:83], v[140:143], v[92:95]
  v_mfma_f32_16x16x32_bf16 v[96:99], a[84:87], v[128:131], v[96:99]
  s_add_u32 s58, s58, 4096
  s_addc_u32 s59, s59, 0
  global_load_dwordx4 a[32:35], v2, s[58:59] offset:0
  v_mfma_f32_16x16x32_bf16 v[100:103], a[84:87], v[132:135], v[100:103]
  v_mfma_f32_16x16x32_bf16 v[104:107], a[84:87], v[136:139], v[104:107]
  v_mfma_f32_16x16x32_bf16 v[108:111], a[84:87], v[140:143], v[108:111]
  global_load_dwordx4 a[36:39], v2, s[58:59] offset:1024
  s_waitcnt lgkmcnt(0)
  v_mfma_f32_16x16x32_bf16 v[64:67], a[88:91], v[112:115], v[64:67]
  ds_read_b128 v[128:131], v39 offset:12288
  v_mfma_f32_16x16x32_bf16 v[68:71], a[88:91], v[116:119], v[68:71]
  ds_read_b128 v[132:135], v39 offset:12544
  v_mfma_f32_16x16x32_bf16 v[72:75], a[88:91], v[120:123], v[72:75]
  ds_read_b128 v[136:139], v39 offset:12800
  v_mfma_f32_16x16x32_bf16 v[76:79], a[88:91], v[124:127], v[76:79]
  ds_read_b128 v[140:143], v39 offset:13056
  v_mfma_f32_16x16x32_bf16 v[80:83], a[92:95], v[112:115], v[80:83]
  v_mfma_f32_16x16x32_bf16 v[84:87], a[92:95], v[116:119], v[84:87]
  global_load_dwordx4 a[40:43], v2, s[58:59] offset:2048
  v_mfma_f32_16x16x32_bf16 v[88:91], a[92:95], v[120:123], v[88:91]
  v_mfma_f32_16x16x32_bf16 v[92:95], a[92:95], v[124:127], v[92:95]
  v_mfma_f32_16x16x32_bf16 v[96:99], a[96:99], v[112:115], v[96:99]
  global_load_dwordx4 a[44:47], v2, s[58:59] offset:3072
  v_mfma_f32_16x16x32_bf16 v[100:103], a[96:99], v[116:119], v[100:103]
  v_mfma_f32_16x16x32_bf16 v[104:107], a[96:99], v[120:123], v[104:107]
  v_mfma_f32_16x16x32_bf16 v[108:111], a[96:99], v[124:127], v[108:111]
  s_add_u32 s58, s58, 4096
  s_addc_u32 s59, s59, 0
  global_load_dwordx4 a[48:51], v2, s[58:59] offset:0
  s_waitcnt lgkmcnt(0)
  v_mfma_f32_16x16x32_bf16 v[64:67], a[100:103], v[128:131], v[64:67]
  v_mfma_f32_16x16x32_bf16 v[68:71], a[100:103], v[132:135], v[68:71]
  v_mfma_f32_16x16x32_bf16 v[72:75], a[100:103], v[136:139], v[72:75]
  v_mfma_f32_16x16x32_bf16 v[76:79], a[100:103], v[140:143], v[76:79]
  v_mfma_f32_16x16x32_bf16 v[80:83], a[104:107], v[128:131], v[80:83]
  v_mfma_f32_16x16x32_bf16 v[84:87], a[104:107], v[132:135], v[84:87]
  global_load_dwordx4 a[52:55], v2, s[58:59] offset:1024
  v_mfma_f32_16x16x32_bf16 v[88:91], a[104:107], v[136:139], v[88:91]
  v_mfma_f32_16x16x32_bf16 v[92:95], a[104:107], v[140:143], v[92:95]
  v_mfma_f32_16x16x32_bf16 v[96:99], a[108:111], v[128:131], v[96:99]
  global_load_dwordx4 a[56:59], v2, s[58:59] offset:2048
  v_mfma_f32_16x16x32_bf16 v[100:103], a[108:111], v[132:135], v[100:103]
  v_mfma_f32_16x16x32_bf16 v[104:107], a[108:111], v[136:139], v[104:107]
  v_mfma_f32_16x16x32_bf16 v[108:111], a[108:111], v[140:143], v[108:111]
  global_load_dwordx4 a[60:63], v2, s[58:59] offset:3072
  v_pk_fma_f32 v[168:169], v[176:177], v[144:145], v[156:157] op_sel_hi:[0,1,1] neg_lo:[1,0,0] neg_hi:[1,0,0]
  v_pk_fma_f32 v[170:171], v[176:177], v[146:147], v[158:159] op_sel_hi:[0,1,1] neg_lo:[1,0,0] neg_hi:[1,0,0]
  v_pk_fma_f32 v[172:173], v[178:179], v[144:145], v[156:157] op_sel_hi:[0,1,1] neg_lo:[1,0,0] neg_hi:[1,0,0]
  v_pk_fma_f32 v[174:175], v[178:179], v[146:147], v[158:159] op_sel_hi:[0,1,1] neg_lo:[1,0,0] neg_hi:[1,0,0]
  v_pk_fma_f32 v[64:65], v[184:185], v[64:65], v[168:169] op_sel_hi:[0,1,1]
  v_pk_fma_f32 v[66:67], v[184:185], v[66:67], v[170:171] op_sel_hi:[0,1,1]
  v_pk_fma_f32 v[68:69], v[186:187], v[68:69], v[172:173] op_sel_hi:[0,1,1]
  v_pk_fma_f32 v[70:71], v[186:187], v[70:71], v[174:175] op_sel_hi:[0,1,1]
  v_pk_mul_f32 v[168:169], v[64:65], v[64:65]
  v_pk_mul_f32 v[170:171], v[66:67], v[66:67]
  v_pk_mul_f32 v[172:173], v[68:69], v[68:69]
  v_pk_mul_f32 v[174:175], v[70:71], v[70:71]
  v_pk_fma_f32 v[168:169], v[168:169], s[50:51], v[192:193] op_sel_hi:[1,0,0]
  v_pk_fma_f32 v[170:171], v[170:171], s[50:51], v[192:193] op_sel_hi:[1,0,0]
  v_pk_fma_f32 v[172:173], v[172:173], s[50:51], v[192:193] op_sel_hi:[1,0,0]
  v_pk_fma_f32 v[174:175], v[174:175], s[50:51], v[192:193] op_sel_hi:[1,0,0]
  v_pk_mul_f32 v[168:169], v[168:169], v[64:65]
  v_pk_mul_f32 v[170:171], v[170:171], v[66:67]
  v_pk_mul_f32 v[172:173], v[172:173], v[68:69]
  v_pk_mul_f32 v[174:175], v[174:175], v[70:71]
  s_add_u32 s58, s58, 4096
  s_addc_u32 s59, s59, 0
  global_load_dwordx4 a[64:67], v2, s[58:59] offset:0
  global_load_dwordx4 a[68:71], v2, s[58:59] offset:1024
  v_exp_f32 v168, v168
  v_exp_f32 v169, v169
  v_exp_f32 v170, v170
  v_exp_f32 v171, v171
  v_exp_f32 v172, v172
  v_exp_f32 v173, v173
  v_exp_f32 v174, v174
  v_exp_f32 v175, v175
  global_load_dwordx4 a[72:75], v2, s[58:59] offset:2048
  v_pk_add_f32 v[168:169], v[168:169], 1.0 op_sel_hi:[1,0]
  v_pk_add_f32 v[170:171], v[170:171], 1.0 op_sel_hi:[1,0]
  v_pk_add_f32 v[172:173], v[172:173], 1.0 op_sel_hi:[1,0]
  v_pk_add_f32 v[174:175], v[174:175], 1.0 op_sel_hi:[1,0]
  v_rcp_f32 v168, v168
  v_rcp_f32 v169, v169
  v_rcp_f32 v170, v170
  v_rcp_f32 v171, v171
  v_rcp_f32 v172, v172
  v_rcp_f32 v173, v173
  v_rcp_f32 v174, v174
  v_rcp_f32 v175, v175
  v_pk_mul_f32 v[64:65], v[64:65], v[168:169]
  v_pk_mul_f32 v[66:67], v[66:67], v[170:171]
  v_pk_mul_f32 v[68:69], v[68:69], v[172:173]
  v_pk_mul_f32 v[70:71], v[70:71], v[174:175]
  global_load_dwordx4 a[76:79], v2, s[58:59] offset:3072
  v_cvt_pk_bf16_f32 v64, v64, v65
  v_cvt_pk_bf16_f32 v65, v66, v67
  buffer_store_dwordx2 v[64:65], v5, s[8:11], s28 offen offset:0 sc1
  v_cvt_pk_bf16_f32 v68, v68, v69
  v_cvt_pk_bf16_f32 v69, v70, v71
  buffer_store_dwordx2 v[68:69], v5, s[8:11], s28 offen offset:256 sc1
  v_pk_fma_f32 v[168:169], v[180:181], v[144:145], v[156:157] op_sel_hi:[0,1,1] neg_lo:[1,0,0] neg_hi:[1,0,0]
  v_pk_fma_f32 v[170:171], v[180:181], v[146:147], v[158:159] op_sel_hi:[0,1,1] neg_lo:[1,0,0] neg_hi:[1,0,0]
  v_pk_fma_f32 v[172:173], v[182:183], v[144:145], v[156:157] op_sel_hi:[0,1,1] neg_lo:[1,0,0] neg_hi:[1,0,0]
  v_pk_fma_f32 v[174:175], v[182:183], v[146:147], v[158:159] op_sel_hi:[0,1,1] neg_lo:[1,0,0] neg_hi:[1,0,0]
  v_pk_fma_f32 v[72:73], v[188:189], v[72:73], v[168:169] op_sel_hi:[0,1,1]
  v_pk_fma_f32 v[74:75], v[188:189], v[74:75], v[170:171] op_sel_hi:[0,1,1]
  v_pk_fma_f32 v[76:77], v[190:191], v[76:77], v[172:173] op_sel_hi:[0,1,1]
  v_pk_fma_f32 v[78:79], v[190:191], v[78:79], v[174:175] op_sel_hi:[0,1,1]
  v_pk_mul_f32 v[168:169], v[72:73], v[72:73]
  v_pk_mul_f32 v[170:171], v[74:75], v[74:75]
  v_pk_mul_f32 v[172:173], v[76:77], v[76:77]
  v_pk_mul_f32 v[174:175], v[78:79], v[78:79]
  v_pk_fma_f32 v[168:169], v[168:169], s[50:51], v[192:193] op_sel_hi:[1,0,0]
  v_pk_fma_f32 v[170:171], v[170:171], s[50:51], v[192:193] op_sel_hi:[1,0,0]
  v_pk_fma_f32 v[172:173], v[172:173], s[50:51], v[192:193] op_sel_hi:[1,0,0]
  v_pk_fma_f32 v[174:175], v[174:175], s[50:51], v[192:193] op_sel_hi:[1,0,0]
  v_pk_mul_f32 v[168:169], v[168:169], v[72:73]
  v_pk_mul_f32 v[170:171], v[170:171], v[74:75]
  v_pk_mul_f32 v[172:173], v[172:173], v[76:77]
  v_pk_mul_f32 v[174:175], v[174:175], v[78:79]
  v_exp_f32 v168, v168
  v_exp_f32 v169, v169
  v_exp_f32 v170, v170
  v_exp_f32 v171, v171
  v_exp_f32 v172, v172
  v_exp_f32 v173, v173
  v_exp_f32 v174, v174
  v_exp_f32 v175, v175
  v_pk_add_f32 v[168:169], v[168:169], 1.0 op_sel_hi:[1,0]
  v_pk_add_f32 v[170:171], v[170:171], 1.0 op_sel_hi:[1,0]
  v_pk_add_f32 v[172:173], v[172:173], 1.0 op_sel_hi:[1,0]
  v_pk_add_f32 v[174:175], v[174:175], 1.0 op_sel_hi:[1,0]
  v_rcp_f32 v168, v168
  v_rcp_f32 v169, v169
  v_rcp_f32 v170, v170
  v_rcp_f32 v171, v171
  v_rcp_f32 v172, v172
  v_rcp_f32 v173, v173
  v_rcp_f32 v174, v174
  v_rcp_f32 v175, v175
  v_pk_mul_f32 v[72:73], v[72:73], v[168:169]
  v_pk_mul_f32 v[74:75], v[74:75], v[170:171]
  v_pk_mul_f32 v[76:77], v[76:77], v[172:173]
  v_pk_mul_f32 v[78:79], v[78:79], v[174:175]
  v_cvt_pk_bf16_f32 v72, v72, v73
  v_cvt_pk_bf16_f32 v73, v74, v75
  buffer_store_dwordx2 v[72:73], v5, s[8:11], s28 offen offset:512 sc1
  v_cvt_pk_bf16_f32 v76, v76, v77
  v_cvt_pk_bf16_f32 v77, v78, v79
  buffer_store_dwordx2 v[76:77], v5, s[8:11], s28 offen offset:768 sc1
  s_add_u32 s28, s28, 2048
  v_pk_fma_f32 v[168:169], v[176:177], v[148:149], v[160:161] op_sel_hi:[0,1,1] neg_lo:[1,0,0] neg_hi:[1,0,0]
  v_pk_fma_f32 v[170:171], v[176:177], v[150:151], v[162:163] op_sel_hi:[0,1,1] neg_lo:[1,0,0] neg_hi:[1,0,0]
  v_pk_fma_f32 v[172:173], v[178:179], v[148:149], v[160:161] op_sel_hi:[0,1,1] neg_lo:[1,0,0] neg_hi:[1,0,0]
  v_pk_fma_f32 v[174:175], v[178:179], v[150:151], v[162:163] op_sel_hi:[0,1,1] neg_lo:[1,0,0] neg_hi:[1,0,0]
  v_pk_fma_f32 v[80:81], v[184:185], v[80:81], v[168:169] op_sel_hi:[0,1,1]
  v_pk_fma_f32 v[82:83], v[184:185], v[82:83], v[170:171] op_sel_hi:[0,1,1]
  v_pk_fma_f32 v[84:85], v[186:187], v[84:85], v[172:173] op_sel_hi:[0,1,1]
  v_pk_fma_f32 v[86:87], v[186:187], v[86:87], v[174:175] op_sel_hi:[0,1,1]
  v_pk_mul_f32 v[168:169], v[80:81], v[80:81]
  v_pk_mul_f32 v[170:171], v[82:83], v[82:83]
  v_pk_mul_f32 v[172:173], v[84:85], v[84:85]
  v_pk_mul_f32 v[174:175], v[86:87], v[86:87]
  v_pk_fma_f32 v[168:169], v[168:169], s[50:51], v[192:193] op_sel_hi:[1,0,0]
  v_pk_fma_f32 v[170:171], v[170:171], s[50:51], v[192:193] op_sel_hi:[1,0,0]
  v_pk_fma_f32 v[172:173], v[172:173], s[50:51], v[192:193] op_sel_hi:[1,0,0]
  v_pk_fma_f32 v[174:175], v[174:175], s[50:51], v[192:193] op_sel_hi:[1,0,0]
  v_pk_mul_f32 v[168:169], v[168:169], v[80:81]
  v_pk_mul_f32 v[170:171], v[170:171], v[82:83]
  v_pk_mul_f32 v[172:173], v[172:173], v[84:85]
  v_pk_mul_f32 v[174:175], v[174:175], v[86:87]
  v_exp_f32 v168, v168
  v_exp_f32 v169, v169
  v_exp_f32 v170, v170
  v_exp_f32 v171, v171
  v_exp_f32 v172, v172
  v_exp_f32 v173, v173
  v_exp_f32 v174, v174
  v_exp_f32 v175, v175
  v_pk_add_f32 v[168:169], v[168:169], 1.0 op_sel_hi:[1,0]
  v_pk_add_f32 v[170:171], v[170:171], 1.0 op_sel_hi:[1,0]
  v_pk_add_f32 v[172:173], v[172:173], 1.0 op_sel_hi:[1,0]
  v_pk_add_f32 v[174:175], v[174:175], 1.0 op_sel_hi:[1,0]
  v_rcp_f32 v168, v168
  v_rcp_f32 v169, v169
  v_rcp_f32 v170, v170
  v_rcp_f32 v171, v171
  v_rcp_f32 v172, v172
  v_rcp_f32 v173, v173
  v_rcp_f32 v174, v174
  v_rcp_f32 v175, v175
  v_pk_mul_f32 v[80:81], v[80:81], v[168:169]
  v_pk_mul_f32 v[82:83], v[82:83], v[170:171]
  v_pk_mul_f32 v[84:85], v[84:85], v[172:173]
  v_pk_mul_f32 v[86:87], v[86:87], v[174:175]
  v_cvt_pk_bf16_f32 v80, v80, v81
  v_cvt_pk_bf16_f32 v81, v82, v83
  buffer_store_dwordx2 v[80:81], v5, s[8:11], s28 offen offset:0 sc1
  v_cvt_pk_bf16_f32 v84, v84, v85
  v_cvt_pk_bf16_f32 v85, v86, v87
  buffer_store_dwordx2 v[84:85], v5, s[8:11], s28 offen offset:256 sc1
  v_pk_fma_f32 v[168:169], v[180:181], v[148:149], v[160:161] op_sel_hi:[0,1,1] neg_lo:[1,0,0] neg_hi:[1,0,0]
  v_pk_fma_f32 v[170:171], v[180:181], v[150:151], v[162:163] op_sel_hi:[0,1,1] neg_lo:[1,0,0] neg_hi:[1,0,0]
  v_pk_fma_f32 v[172:173], v[182:183], v[148:149], v[160:161] op_sel_hi:[0,1,1] neg_lo:[1,0,0] neg_hi:[1,0,0]
  v_pk_fma_f32 v[174:175], v[182:183], v[150:151], v[162:163] op_sel_hi:[0,1,1] neg_lo:[1,0,0] neg_hi:[1,0,0]
  v_pk_fma_f32 v[88:89], v[188:189], v[88:89], v[168:169] op_sel_hi:[0,1,1]
  v_pk_fma_f32 v[90:91], v[188:189], v[90:91], v[170:171] op_sel_hi:[0,1,1]
  v_pk_fma_f32 v[92:93], v[190:191], v[92:93], v[172:173] op_sel_hi:[0,1,1]
  v_pk_fma_f32 v[94:95], v[190:191], v[94:95], v[174:175] op_sel_hi:[0,1,1]
  v_pk_mul_f32 v[168:169], v[88:89], v[88:89]
  v_pk_mul_f32 v[170:171], v[90:91], v[90:91]
  v_pk_mul_f32 v[172:173], v[92:93], v[92:93]
  v_pk_mul_f32 v[174:175], v[94:95], v[94:95]
  v_pk_fma_f32 v[168:169], v[168:169], s[50:51], v[192:193] op_sel_hi:[1,0,0]
  v_pk_fma_f32 v[170:171], v[170:171], s[50:51], v[192:193] op_sel_hi:[1,0,0]
  v_pk_fma_f32 v[172:173], v[172:173], s[50:51], v[192:193] op_sel_hi:[1,0,0]
  v_pk_fma_f32 v[174:175], v[174:175], s[50:51], v[192:193] op_sel_hi:[1,0,0]
  v_pk_mul_f32 v[168:169], v[168:169], v[88:89]
  v_pk_mul_f32 v[170:171], v[170:171], v[90:91]
  v_pk_mul_f32 v[172:173], v[172:173], v[92:93]
  v_pk_mul_f32 v[174:175], v[174:175], v[94:95]
  v_exp_f32 v168, v168
  v_exp_f32 v169, v169
  v_exp_f32 v170, v170
  v_exp_f32 v171, v171
  v_exp_f32 v172, v172
  v_exp_f32 v173, v173
  v_exp_f32 v174, v174
  v_exp_f32 v175, v175
  v_pk_add_f32 v[168:169], v[168:169], 1.0 op_sel_hi:[1,0]
  v_pk_add_f32 v[170:171], v[170:171], 1.0 op_sel_hi:[1,0]
  v_pk_add_f32 v[172:173], v[172:173], 1.0 op_sel_hi:[1,0]
  v_pk_add_f32 v[174:175], v[174:175], 1.0 op_sel_hi:[1,0]
  v_rcp_f32 v168, v168
  v_rcp_f32 v169, v169
  v_rcp_f32 v170, v170
  v_rcp_f32 v171, v171
  v_rcp_f32 v172, v172
  v_rcp_f32 v173, v173
  v_rcp_f32 v174, v174
  v_rcp_f32 v175, v175
  v_pk_mul_f32 v[88:89], v[88:89], v[168:169]
  v_pk_mul_f32 v[90:91], v[90:91], v[170:171]
  v_pk_mul_f32 v[92:93], v[92:93], v[172:173]
  v_pk_mul_f32 v[94:95], v[94:95], v[174:175]
  v_cvt_pk_bf16_f32 v88, v88, v89
  v_cvt_pk_bf16_f32 v89, v90, v91
  buffer_store_dwordx2 v[88:89], v5, s[8:11], s28 offen offset:512 sc1
  v_cvt_pk_bf16_f32 v92, v92, v93
  v_cvt_pk_bf16_f32 v93, v94, v95
  buffer_store_dwordx2 v[92:93], v5, s[8:11], s28 offen offset:768 sc1
  s_add_u32 s28, s28, 2048
  v_pk_fma_f32 v[168:169], v[176:177], v[152:153], v[164:165] op_sel_hi:[0,1,1] neg_lo:[1,0,0] neg_hi:[1,0,0]
  v_pk_fma_f32 v[170:171], v[176:177], v[154:155], v[166:167] op_sel_hi:[0,1,1] neg_lo:[1,0,0] neg_hi:[1,0,0]
  v_pk_fma_f32 v[172:173], v[178:179], v[152:153], v[164:165] op_sel_hi:[0,1,1] neg_lo:[1,0,0] neg_hi:[1,0,0]
  v_pk_fma_f32 v[174:175], v[178:179], v[154:155], v[166:167] op_sel_hi:[0,1,1] neg_lo:[1,0,0] neg_hi:[1,0,0]
  v_pk_fma_f32 v[96:97], v[184:185], v[96:97], v[168:169] op_sel_hi:[0,1,1]
  v_pk_fma_f32 v[98:99], v[184:185], v[98:99], v[170:171] op_sel_hi:[0,1,1]
  v_pk_fma_f32 v[100:101], v[186:187], v[100:101], v[172:173] op_sel_hi:[0,1,1]
  v_pk_fma_f32 v[102:103], v[186:187], v[102:103], v[174:175] op_sel_hi:[0,1,1]
  v_pk_mul_f32 v[168:169], v[96:97], v[96:97]
  v_pk_mul_f32 v[170:171], v[98:99], v[98:99]
  v_pk_mul_f32 v[172:173], v[100:101], v[100:101]
  v_pk_mul_f32 v[174:175], v[102:103], v[102:103]
  v_pk_fma_f32 v[168:169], v[168:169], s[50:51], v[192:193] op_sel_hi:[1,0,0]
  v_pk_fma_f32 v[170:171], v[170:171], s[50:51], v[192:193] op_sel_hi:[1,0,0]
  v_pk_fma_f32 v[172:173], v[172:173], s[50:51], v[192:193] op_sel_hi:[1,0,0]
  v_pk_fma_f32 v[174:175], v[174:175], s[50:51], v[192:193] op_sel_hi:[1,0,0]
  v_pk_mul_f32 v[168:169], v[168:169], v[96:97]
  v_pk_mul_f32 v[170:171], v[170:171], v[98:99]
  v_pk_mul_f32 v[172:173], v[172:173], v[100:101]
  v_pk_mul_f32 v[174:175], v[174:175], v[102:103]
  v_exp_f32 v168, v168
  v_exp_f32 v169, v169
  v_exp_f32 v170, v170
  v_exp_f32 v171, v171
  v_exp_f32 v172, v172
  v_exp_f32 v173, v173
  v_exp_f32 v174, v174
  v_exp_f32 v175, v175
  v_pk_add_f32 v[168:169], v[168:169], 1.0 op_sel_hi:[1,0]
  v_pk_add_f32 v[170:171], v[170:171], 1.0 op_sel_hi:[1,0]
  v_pk_add_f32 v[172:173], v[172:173], 1.0 op_sel_hi:[1,0]
  v_pk_add_f32 v[174:175], v[174:175], 1.0 op_sel_hi:[1,0]
  v_rcp_f32 v168, v168
  v_rcp_f32 v169, v169
  v_rcp_f32 v170, v170
  v_rcp_f32 v171, v171
  v_rcp_f32 v172, v172
  v_rcp_f32 v173, v173
  v_rcp_f32 v174, v174
  v_rcp_f32 v175, v175
  v_pk_mul_f32 v[96:97], v[96:97], v[168:169]
  v_pk_mul_f32 v[98:99], v[98:99], v[170:171]
  v_pk_mul_f32 v[100:101], v[100:101], v[172:173]
  v_pk_mul_f32 v[102:103], v[102:103], v[174:175]
  v_cvt_pk_bf16_f32 v96, v96, v97
  v_cvt_pk_bf16_f32 v97, v98, v99
  buffer_store_dwordx2 v[96:97], v5, s[8:11], s28 offen offset:0 sc1
  v_cvt_pk_bf16_f32 v100, v100, v101
  v_cvt_pk_bf16_f32 v101, v102, v103
  buffer_store_dwordx2 v[100:101], v5, s[8:11], s28 offen offset:256 sc1
  v_pk_fma_f32 v[168:169], v[180:181], v[152:153], v[164:165] op_sel_hi:[0,1,1] neg_lo:[1,0,0] neg_hi:[1,0,0]
  v_pk_fma_f32 v[170:171], v[180:181], v[154:155], v[166:167] op_sel_hi:[0,1,1] neg_lo:[1,0,0] neg_hi:[1,0,0]
  v_pk_fma_f32 v[172:173], v[182:183], v[152:153], v[164:165] op_sel_hi:[0,1,1] neg_lo:[1,0,0] neg_hi:[1,0,0]
  v_pk_fma_f32 v[174:175], v[182:183], v[154:155], v[166:167] op_sel_hi:[0,1,1] neg_lo:[1,0,0] neg_hi:[1,0,0]
  v_pk_fma_f32 v[104:105], v[188:189], v[104:105], v[168:169] op_sel_hi:[0,1,1]
  v_pk_fma_f32 v[106:107], v[188:189], v[106:107], v[170:171] op_sel_hi:[0,1,1]
  v_pk_fma_f32 v[108:109], v[190:191], v[108:109], v[172:173] op_sel_hi:[0,1,1]
  v_pk_fma_f32 v[110:111], v[190:191], v[110:111], v[174:175] op_sel_hi:[0,1,1]
  v_pk_mul_f32 v[168:169], v[104:105], v[104:105]
  v_pk_mul_f32 v[170:171], v[106:107], v[106:107]
  v_pk_mul_f32 v[172:173], v[108:109], v[108:109]
  v_pk_mul_f32 v[174:175], v[110:111], v[110:111]
  v_pk_fma_f32 v[168:169], v[168:169], s[50:51], v[192:193] op_sel_hi:[1,0,0]
  v_pk_fma_f32 v[170:171], v[170:171], s[50:51], v[192:193] op_sel_hi:[1,0,0]
  v_pk_fma_f32 v[172:173], v[172:173], s[50:51], v[192:193] op_sel_hi:[1,0,0]
  v_pk_fma_f32 v[174:175], v[174:175], s[50:51], v[192:193] op_sel_hi:[1,0,0]
  v_pk_mul_f32 v[168:169], v[168:169], v[104:105]
  v_pk_mul_f32 v[170:171], v[170:171], v[106:107]
  v_pk_mul_f32 v[172:173], v[172:173], v[108:109]
  v_pk_mul_f32 v[174:175], v[174:175], v[110:111]
  v_exp_f32 v168, v168
  v_exp_f32 v169, v169
  v_exp_f32 v170, v170
  v_exp_f32 v171, v171
  v_exp_f32 v172, v172
  v_exp_f32 v173, v173
  v_exp_f32 v174, v174
  v_exp_f32 v175, v175
  v_pk_add_f32 v[168:169], v[168:169], 1.0 op_sel_hi:[1,0]
  v_pk_add_f32 v[170:171], v[170:171], 1.0 op_sel_hi:[1,0]
  v_pk_add_f32 v[172:173], v[172:173], 1.0 op_sel_hi:[1,0]
  v_pk_add_f32 v[174:175], v[174:175], 1.0 op_sel_hi:[1,0]
  v_rcp_f32 v168, v168
  v_rcp_f32 v169, v169
  v_rcp_f32 v170, v170
  v_rcp_f32 v171, v171
  v_rcp_f32 v172, v172
  v_rcp_f32 v173, v173
  v_rcp_f32 v174, v174
  v_rcp_f32 v175, v175
  v_pk_mul_f32 v[104:105], v[104:105], v[168:169]
  v_pk_mul_f32 v[106:107], v[106:107], v[170:171]
  v_pk_mul_f32 v[108:109], v[108:109], v[172:173]
  v_pk_mul_f32 v[110:111], v[110:111], v[174:175]
  v_cvt_pk_bf16_f32 v104, v104, v105
  v_cvt_pk_bf16_f32 v105, v106, v107
  buffer_store_dwordx2 v[104:105], v5, s[8:11], s28 offen offset:512 sc1
  v_cvt_pk_bf16_f32 v108, v108, v109
  v_cvt_pk_bf16_f32 v109, v110, v111
  buffer_store_dwordx2 v[108:109], v5, s[8:11], s28 offen offset:768 sc1
  s_waitcnt vmcnt(0)
  s_barrier
  s_cmp_lg_u32 s18, 0
  s_cbranch_scc1 ARR_s3
  v_mov_b32 v6, 0
  v_mov_b32 v7, 1
  s_mov_b64 exec, 1
  buffer_atomic_add v7, v6, s[8:11], s53 offen sc1
  s_mov_b64 exec, -1
ARR_s3:
  s_nop 0
  s_add_u32 s52, s52, 8
  s_add_u32 s47, s42, 53248
  s_add_u32 s58, s4, s47
  s_addc_u32 s59, s5, 0
  global_load_dwordx4 a[80:83], v2, s[58:59] offset:0
  global_load_dwordx4 a[84:87], v2, s[58:59] offset:1024
  global_load_dwordx4 a[88:91], v2, s[58:59] offset:2048
  global_load_dwordx4 a[92:95], v2, s[58:59] offset:3072
  s_add_u32 s58, s58, 4096
  s_addc_u32 s59, s59, 0
  global_load_dwordx4 a[96:99], v2, s[58:59] offset:0
  global_load_dwordx4 a[100:103], v2, s[58:59] offset:1024
  v_mov_b32 v253, 0
  s_cmp_lg_u32 s18, 0
  s_cbranch_scc1 PL0_s3
  buffer_load_dword v254, v253, s[8:11], s53 offen sc1
PL0_s3:
  global_load_dwordx4 a[104:107], v2, s[58:59] offset:2048
  global_load_dwordx4 a[108:111], v2, s[58:59] offset:3072
  v_lshrrev_b32 v6, 4, v1
  v_lshlrev_b32 v6, 4, v6
  v_add_u32 v56, 161792, v6
  ds_read_b128 v[160:163], v56 offset:0
  ds_read_b128 v[164:167], v56 offset:64
  ds_read_b128 v[168:171], v56 offset:128
  ds_read_b128 v[172:175], v56 offset:192
  ds_read_b128 v[176:179], v56 offset:256
  v_lshlrev_b32 v26, 16, v240
  v_and_b32 v27, 0xffff0000, v240
  s_waitcnt lgkmcnt(4)
  v_pk_add_f32 v[160:161], v[160:161], v[26:27]
  v_lshlrev_b32 v26, 16, v241
  v_and_b32 v27, 0xffff0000, v241
  v_pk_add_f32 v[162:163], v[162:163], v[26:27]
  v_lshlrev_b32 v26, 16, v242
  v_and_b32 v27, 0xffff0000, v242
  s_waitcnt lgkmcnt(3)
  v_pk_add_f32 v[164:165], v[164:165], v[26:27]
  v_lshlrev_b32 v26, 16, v243
  v_and_b32 v27, 0xffff0000, v243
  v_pk_add_f32 v[166:167], v[166:167], v[26:27]
  v_lshlrev_b32 v26, 16, v244
  v_and_b32 v27, 0xffff0000, v244
  s_waitcnt lgkmcnt(2)
  v_pk_add_f32 v[168:169], v[168:169], v[26:27]
  v_lshlrev_b32 v26, 16, v245
  v_and_b32 v27, 0xffff0000, v245
  v_pk_add_f32 v[170:171], v[170:171], v[26:27]
  v_lshlrev_b32 v26, 16, v246
  v_and_b32 v27, 0xffff0000, v246
  s_waitcnt lgkmcnt(1)
  v_pk_add_f32 v[172:173], v[172:173], v[26:27]
  v_lshlrev_b32 v26, 16, v247
  v_and_b32 v27, 0xffff0000, v247
  v_pk_add_f32 v[174:175], v[174:175], v[26:27]
  v_lshlrev_b32 v26, 16, v248
  v_and_b32 v27, 0xffff0000, v248
  s_waitcnt lgkmcnt(0)
  v_pk_add_f32 v[176:177], v[176:177], v[26:27]
  v_lshlrev_b32 v26, 16, v249
  v_and_b32 v27, 0xffff0000, v249
  v_pk_add_f32 v[178:179], v[178:179], v[26:27]
  s_cmp_lg_u32 s18, 0
  s_cbranch_scc1 POLLE_s3
  s_waitcnt vmcnt(2)
  s_mov_b32 s23, 0
  v_cmp_le_u32 vcc, s52, v254
  s_nop 3
  s_cmp_eq_u64 vcc, exec
  s_cbranch_scc1 POLLD_s3
POLL_s3:
  buffer_load_dword v254, v253, s[8:11], s53 offen sc1
  s_waitcnt vmcnt(0)
  s_add_u32 s23, s23, 1
  v_cmp_le_u32 vcc, s52, v254
  s_nop 3
  s_cmp_eq_u64 vcc, exec
  s_cbranch_scc1 POLLD_s3
  s_cmp_lt_u32 s23, 400000
  s_cbranch_scc1 POLL_s3
POLLD_s3:
POLLE_s3:
  s_barrier
  s_add_u32 s21, s18, 0
  s_and_b32 s22, s21, 1
  s_lshl_b32 s22, s22, 1
  s_bfe_u32 s21, s21, 0x10001
  s_or_b32 s21, s21, s22
  s_mov_b32 s31, s21
  s_lshl_b32 s21, s21, 8
  v_add_u32 v48, s21, v3
  s_add_u32 s21, s18, 1
  s_and_b32 s22, s21, 1
  s_lshl_b32 s22, s22, 1
  s_bfe_u32 s21, s21, 0x10001
  s_or_b32 s21, s21, s22
  s_lshl_b32 s21, s21, 8
  v_add_u32 v49, s21, v3
  s_add_u32 s21, s18, 2
  s_and_b32 s22, s21, 1
  s_lshl_b32 s22, s22, 1
  s_bfe_u32 s21, s21, 0x10001
  s_or_b32 s21, s21, s22
  s_lshl_b32 s21, s21, 8
  v_add_u32 v50, s21, v3
  s_add_u32 s21, s18, 3
  s_and_b32 s22, s21, 1
  s_lshl_b32 s22, s22, 1
  s_bfe_u32 s21, s21, 0x10001
  s_or_b32 s21, s21, s22
  s_lshl_b32 s21, s21, 8
  v_add_u32 v51, s21, v3
  s_mul_i32 s26, s16, 196608
  s_add_u32 s26, s26, s20
  s_mul_i32 s21, s18, 49152
  s_add_u32 s26, s26, s21
  s_add_u32 s26, s26, 0x1d52000
  buffer_load_dwordx4 v[64:67], v48, s[8:11], s26 offen sc1
  buffer_load_dwordx4 v[68:71], v49, s[8:11], s26 offen sc1
  buffer_load_dwordx4 v[72:75], v50, s[8:11], s26 offen sc1
  buffer_load_dwordx4 v[76:79], v51, s[8:11], s26 offen sc1
  s_add_u32 s26, s26, 4096
  buffer_load_dwordx4 v[80:83], v48, s[8:11], s26 offen sc1
  buffer_load_dwordx4 v[84:87], v49, s[8:11], s26 offen sc1
  buffer_load_dwordx4 v[88:91], v50, s[8:11], s26 offen sc1
  buffer_load_dwordx4 v[92:95], v51, s[8:11], s26 offen sc1
  s_add_u32 s26, s26, 4096
  s_mul_i32 s21, s17, 10240
  s_add_u32 s27, s43, s21
  s_lshl_b32 s21, s31, 8
  s_add_u32 s27, s27, s21
  s_add_u32 s28, s27, 0x2352000
  s_add_u32 s21, s18, 1
  s_and_b32 s21, s21, 3
  s_mul_i32 s21, s21, 15360
  s_add_u32 s21, s21, 0
  v_add_u32 v52, s21, v2
  s_add_u32 s21, s18, 2
  s_and_b32 s21, s21, 3
  s_mul_i32 s21, s21, 15360
  s_add_u32 s21, s21, 5120
  v_add_u32 v53, s21, v2
  s_add_u32 s21, s18, 3
  s_and_b32 s21, s21, 3
  s_mul_i32 s21, s21, 15360
  s_add_u32 s21, s21, 10240
  v_add_u32 v54, s21, v2
  s_mul_i32 s21, s18, 15360
  s_add_u32 s21, s21, 0
  v_add_u32 v55, s21, v2
  s_lshl_b32 s29, s16, 12
  s_lshl_b32 s21, s17, 9
  s_add_u32 s29, s29, s21
  s_lshl_b32 s21, s31, 7
  s_add_u32 s29, s29, s21
  s_add_u32 s29, s29, 0x25d2000
  v_lshlrev_b32 v6, 3, v1
  v_cmp_gt_u32 vcc, 16, v1
  v_mov_b32 v7, 0x40000000
  s_nop 0
  v_cndmask_b32 v28, v7, v6, vcc
  s_waitcnt vmcnt(4)
  v_mfma_f32_16x16x32_bf16 v[160:163], a[128:131], v[64:67], v[160:163]
  v_mfma_f32_16x16x32_bf16 v[180:183], a[128:131], v[68:71], 0
  v_mfma_f32_16x16x32_bf16 v[200:203], a[128:131], v[72:75], 0
  buffer_load_dwordx4 v[96:99], v48, s[8:11], s26 offen sc1
  v_mfma_f32_16x16x32_bf16 v[220:223], a[128:131], v[76:79], 0
  v_mfma_f32_16x16x32_bf16 v[164:167], a[132:135], v[64:67], v[164:167]
  v_mfma_f32_16x16x32_bf16 v[184:187], a[132:135], v[68:71], 0
  v_mfma_f32_16x16x32_bf16 v[204:207], a[132:135], v[72:75], 0
  buffer_load_dwordx4 v[100:103], v49, s[8:11], s26 offen sc1
  v_mfma_f32_16x16x32_bf16 v[224:227], a[132:135], v[76:79], 0
  v_mfma_f32_16x16x32_bf16 v[168:171], a[136:139], v[64:67], v[168:171]
  v_mfma_f32_16x16x32_bf16 v[188:191], a[136:139], v[68:71], 0
  v_mfma_f32_16x16x32_bf16 v[208:211], a[136:139], v[72:75], 0
  buffer_load_dwordx4 v[104:107], v50, s[8:11], s26 offen sc1
  v_mfma_f32_16x16x32_bf16 v[228:231], a[136:139], v[76:79], 0
  v_mfma_f32_16x16x32_bf16 v[172:175], a[140:143], v[64:67], v[172:175]
  v_mfma_f32_16x16x32_bf16 v[192:195], a[140:143], v[68:71], 0
  v_mfma_f32_16x16x32_bf16 v[212:215], a[140:143], v[72:75], 0
  buffer_load_dwordx4 v[108:111], v51, s[8:11], s26 offen sc1
  s_add_u32 s26, s26, 4096
  v_mfma_f32_16x16x32_bf16 v[232:235], a[140:143], v[76:79], 0
  v_mfma_f32_16x16x32_bf16 v[176:179], a[144:147], v[64:67], v[176:179]
  v_mfma_f32_16x16x32_bf16 v[196:199], a[144:147], v[68:71], 0
  v_mfma_f32_16x16x32_bf16 v[216:219], a[144:147], v[72:75], 0
  buffer_load_dwordx4 v[112:115], v48, s[8:11], s26 offen sc1
  v_mfma_f32_16x16x32_bf16 v[236:239], a[144:147], v[76:79], 0
  s_waitcnt vmcnt(5)
  v_mfma_f32_16x16x32_bf16 v[160:163], a[148:151], v[80:83], v[160:163]
  v_mfma_f32_16x16x32_bf16 v[180:183], a[148:151], v[84:87], v[180:183]
  v_mfma_f32_16x16x32_bf16 v[200:203], a[148:151], v[88:91], v[200:203]
  buffer_load_dwordx4 v[116:119], v49, s[8:11], s26 offen sc1
  v_mfma_f32_16x16x32_bf16 v[220:223], a[148:151], v[92:95], v[220:223]
  v_mfma_f32_16x16x32_bf16 v[164:167], a[152:155], v[80:83], v[164:167]
  v_mfma_f32_16x16x32_bf16 v[184:187], a[152:155], v[84:87], v[184:187]
  v_mfma_f32_16x16x32_bf16 v[204:207], a[152:155], v[88:91], v[204:207]
  buffer_load_dwordx4 v[120:123], v50, s[8:11], s26 offen sc1
  v_mfma_f32_16x16x32_bf16 v[224:227], a[152:155], v[92:95], v[224:227]
  v_mfma_f32_16x16x32_bf16 v[168:171], a[156:159], v[80:83], v[168:171]
  v_mfma_f32_16x16x32_bf16 v[188:191], a[156:159], v[84:87], v[188:191]
  v_mfma_f32_16x16x32_bf16 v[208:211], a[156:159], v[88:91], v[208:211]
  buffer_load_dwordx4 v[124:127], v51, s[8:11], s26 offen sc1
  s_add_u32 s26, s26, 4096
  v_mfma_f32_16x16x32_bf16 v[228:231], a[156:159], v[92:95], v[228:231]
  v_mfma_f32_16x16x32_bf16 v[172:175], a[160:163], v[80:83], v[172:175]
  v_mfma_f32_16x16x32_bf16 v[192:195], a[160:163], v[84:87], v[192:195]
  v_mfma_f32_16x16x32_bf16 v[212:215], a[160:163], v[88:91], v[212:215]
  buffer_load_dwordx4 v[128:131], v48, s[8:11], s26 offen sc1
  v_mfma_f32_16x16x32_bf16 v[232:235], a[160:163], v[92:95], v[232:235]
  v_mfma_f32_16x16x32_bf16 v[176:179], a[164:167], v[80:83], v[176:179]
  v_mfma_f32_16x16x32_bf16 v[196:199], a[164:167], v[84:87], v[196:199]
  v_mfma_f32_16x16x32_bf16 v[216:219], a[164:167], v[88:91], v[216:219]
  buffer_load_dwordx4 v[132:135], v49, s[8:11], s26 offen sc1
  v_mfma_f32_16x16x32_bf16 v[236:239], a[164:167], v[92:95], v[236:239]
  s_waitcnt vmcnt(6)
  v_mfma_f32_16x16x32_bf16 v[160:163], a[168:171], v[96:99], v[160:163]
  v_mfma_f32_16x16x32_bf16 v[180:183], a[168:171], v[100:103], v[180:183]
  v_mfma_f32_16x16x32_bf16 v[200:203], a[168:171], v[104:107], v[200:203]
  buffer_load_dwordx4 v[136:139], v50, s[8:11], s26 offen sc1
  v_mfma_f32_16x16x32_bf16 v[220:223], a[168:171], v[108:111], v[220:223]
  v_mfma_f32_16x16x32_bf16 v[164:167], a[172:175], v[96:99], v[164:167]
  v_mfma_f32_16x16x32_bf16 v[184:187], a[172:175], v[100:103], v[184:187]
  v_mfma_f32_16x16x32_bf16 v[204:207], a[172:175], v[104:107], v[204:207]
  buffer_load_dwordx4 v[140:143], v51, s[8:11], s26 offen sc1
  s_add_u32 s26, s26, 4096
  v_mfma_f32_16x16x32_bf16 v[224:227], a[172:175], v[108:111], v[224:227]
  v_mfma_f32_16x16x32_bf16 v[168:171], a[176:179], v[96:99], v[168:171]
  v_mfma_f32_16x16x32_bf16 v[188:191], a[176:179], v[100:103], v[188:191]
  v_mfma_f32_16x16x32_bf16 v[208:211], a[176:179], v[104:107], v[208:211]
  buffer_load_dwordx4 v[144:147], v48, s[8:11], s26 offen sc1
  v_mfma_f32_16x16x32_bf16 v[228:231], a[176:179], v[108:111], v[228:231]
  v_mfma_f32_16x16x32_bf16 v[172:175], a[180:183], v[96:99], v[172:175]
  v_mfma_f32_16x16x32_bf16 v[192:195], a[180:183], v[100:103], v[192:195]
  v_mfma_f32_16x16x32_bf16 v[212:215], a[180:183], v[104:107], v[212:215]
  buffer_load_dwordx4 v[148:151], v49, s[8:11], s26 offen sc1
  v_mfma_f32_16x16x32_bf16 v[232:235], a[180:183], v[108:111], v[232:235]
  v_mfma_f32_16x16x32_bf16 v[176:179], a[184:187], v[96:99], v[176:179]
  v_mfma_f32_16x16x32_bf16 v[196:199], a[184:187], v[100:103], v[196:199]
  v_mfma_f32_16x16x32_bf16 v[216:219], a[184:187], v[104:107], v[216:219]
  buffer_load_dwordx4 v[152:155], v50, s[8:11], s26 offen sc1
  v_mfma_f32_16x16x32_bf16 v[236:239], a[184:187], v[108:111], v[236:239]
  s_waitcnt vmcnt(7)
  v_mfma_f32_16x16x32_bf16 v[160:163], a[188:191], v[112:115], v[160:163]
  v_mfma_f32_16x16x32_bf16 v[180:183], a[188:191], v[116:119], v[180:183]
  v_mfma_f32_16x16x32_bf16 v[200:203], a[188:191], v[120:123], v[200:203]
  buffer_load_dwordx4 v[156:159], v51, s[8:11], s26 offen sc1
  s_add_u32 s26, s26, 4096
  v_mfma_f32_16x16x32_bf16 v[220:223], a[188:191], v[124:127], v[220:223]
  v_mfma_f32_16x16x32_bf16 v[164:167], a[192:195], v[112:115], v[164:167]
  v_mfma_f32_16x16x32_bf16 v[184:187], a[192:195], v[116:119], v[184:187]
  v_mfma_f32_16x16x32_bf16 v[204:207], a[192:195], v[120:123], v[204:207]
  buffer_load_dwordx4 v[64:67], v48, s[8:11], s26 offen sc1
  v_mfma_f32_16x16x32_bf16 v[224:227], a[192:195], v[124:127], v[224:227]
  v_mfma_f32_16x16x32_bf16 v[168:171], a[196:199], v[112:115], v[168:171]
  v_mfma_f32_16x16x32_bf16 v[188:191], a[196:199], v[116:119], v[188:191]
  v_mfma_f32_16x16x32_bf16 v[208:211], a[196:199], v[120:123], v[208:211]
  buffer_load_dwordx4 v[68:71], v49, s[8:11], s26 offen sc1
  v_mfma_f32_16x16x32_bf16 v[228:231], a[196:199], v[124:127], v[228:231]
  v_mfma_f32_16x16x32_bf16 v[172:175], a[200:203], v[112:115], v[172:175]
  v_mfma_f32_16x16x32_bf16 v[192:195], a[200:203], v[116:119], v[192:195]
  v_mfma_f32_16x16x32_bf16 v[212:215], a[200:203], v[120:123], v[212:215]
  buffer_load_dwordx4 v[72:75], v50, s[8:11], s26 offen sc1
  v_mfma_f32_16x16x32_bf16 v[232:235], a[200:203], v[124:127], v[232:235]
  v_mfma_f32_16x16x32_bf16 v[176:179], a[204:207], v[112:115], v[176:179]
  v_mfma_f32_16x16x32_bf16 v[196:199], a[204:207], v[116:119], v[196:199]
  v_mfma_f32_16x16x32_bf16 v[216:219], a[204:207], v[120:123], v[216:219]
  buffer_load_dwordx4 v[76:79], v51, s[8:11], s26 offen sc1
  s_add_u32 s26, s26, 4096
  v_mfma_f32_16x16x32_bf16 v[236:239], a[204:207], v[124:127], v[236:239]
  s_waitcnt vmcnt(8)
  v_mfma_f32_16x16x32_bf16 v[160:163], a[208:211], v[128:131], v[160:163]
  v_mfma_f32_16x16x32_bf16 v[180:183], a[208:211], v[132:135], v[180:183]
  v_mfma_f32_16x16x32_bf16 v[200:203], a[208:211], v[136:139], v[200:203]
  buffer_load_dwordx4 v[80:83], v48, s[8:11], s26 offen sc1
  v_mfma_f32_16x16x32_bf16 v[220:223], a[208:211], v[140:143], v[220:223]
  v_mfma_f32_16x16x32_bf16 v[164:167], a[212:215], v[128:131], v[164:167]
  v_mfma_f32_16x16x32_bf16 v[184:187], a[212:215], v[132:135], v[184:187]
  v_mfma_f32_16x16x32_bf16 v[204:207], a[212:215], v[136:139], v[204:207]
  buffer_load_dwordx4 v[84:87], v49, s[8:11], s26 offen sc1
  v_mfma_f32_16x16x32_bf16 v[224:227], a[212:215], v[140:143], v[224:227]
  v_mfma_f32_16x16x32_bf16 v[168:171], a[216:219], v[128:131], v[168:171]
  v_mfma_f32_16x16x32_bf16 v[188:191], a[216:219], v[132:135], v[188:191]
  v_mfma_f32_16x16x32_bf16 v[208:211], a[216:219], v[136:139], v[208:211]
  buffer_load_dwordx4 v[88:91], v50, s[8:11], s26 offen sc1
  v_mfma_f32_16x16x32_bf16 v[228:231], a[216:219], v[140:143], v[228:231]
  v_mfma_f32_16x16x32_bf16 v[172:175], a[220:223], v[128:131], v[172:175]
  v_mfma_f32_16x16x32_bf16 v[192:195], a[220:223], v[132:135], v[192:195]
  v_mfma_f32_16x16x32_bf16 v[212:215], a[220:223], v[136:139], v[212:215]
  buffer_load_dwordx4 v[92:95], v51, s[8:11], s26 offen sc1
  s_add_u32 s26, s26, 4096
  v_mfma_f32_16x16x32_bf16 v[232:235], a[220:223], v[140:143], v[232:235]
  v_mfma_f32_16x16x32_bf16 v[176:179], a[224:227], v[128:131], v[176:179]
  v_mfma_f32_16x16x32_bf16 v[196:199], a[224:227], v[132:135], v[196:199]
  v_mfma_f32_16x16x32_bf16 v[216:219], a[224:227], v[136:139], v[216:219]
  buffer_load_dwordx4 v[96:99], v48, s[8:11], s26 offen sc1
  v_mfma_f32_16x16x32_bf16 v[236:239], a[224:227], v[140:143], v[236:239]
  s_waitcnt vmcnt(9)
  v_mfma_f32_16x16x32_bf16 v[160:163], a[228:231], v[144:147], v[160:163]
  v_mfma_f32_16x16x32_bf16 v[180:183], a[228:231], v[148:151], v[180:183]
  v_mfma_f32_16x16x32_bf16 v[200:203], a[228:231], v[152:155], v[200:203]
  buffer_load_dwordx4 v[100:103], v49, s[8:11], s26 offen sc1
  v_mfma_f32_16x16x32_bf16 v[220:223], a[228:231], v[156:159], v[220:223]
  v_mfma_f32_16x16x32_bf16 v[164:167], a[232:235], v[144:147], v[164:167]
  v_mfma_f32_16x16x32_bf16 v[184:187], a[232:235], v[148:151], v[184:187]
  v_mfma_f32_16x16x32_bf16 v[204:207], a[232:235], v[152:155], v[204:207]
  buffer_load_dwordx4 v[104:107], v50, s[8:11], s26 offen sc1
  v_mfma_f32_16x16x32_bf16 v[224:227], a[232:235], v[156:159], v[224:227]
  v_mfma_f32_16x16x32_bf16 v[168:171], a[236:239], v[144:147], v[168:171]
  v_mfma_f32_16x16x32_bf16 v[188:191], a[236:239], v[148:151], v[188:191]
  v_mfma_f32_16x16x32_bf16 v[208:211], a[236:239], v[152:155], v[208:211]
  buffer_load_dwordx4 v[108:111], v51, s[8:11], s26 offen sc1
  s_add_u32 s26, s26, 4096
  v_mfma_f32_16x16x32_bf16 v[228:231], a[236:239], v[156:159], v[228:231]
  v_mfma_f32_16x16x32_bf16 v[172:175], a[240:243], v[144:147], v[172:175]
  v_mfma_f32_16x16x32_bf16 v[192:195], a[240:243], v[148:151], v[192:195]
  v_mfma_f32_16x16x32_bf16 v[212:215], a[240:243], v[152:155], v[212:215]
  s_add_u32 s30, s26, 0
  buffer_load_dwordx4 v[116:119], v49, s[8:11], s30 offen sc1
  v_mfma_f32_16x16x32_bf16 v[232:235], a[240:243], v[156:159], v[232:235]
  v_mfma_f32_16x16x32_bf16 v[176:179], a[244:247], v[144:147], v[176:179]
  v_mfma_f32_16x16x32_bf16 v[196:199], a[244:247], v[148:151], v[196:199]
  v_mfma_f32_16x16x32_bf16 v[216:219], a[244:247], v[152:155], v[216:219]
  s_add_u32 s30, s26, 4096
  buffer_load_dwordx4 v[132:135], v49, s[8:11], s30 offen sc1
  v_mfma_f32_16x16x32_bf16 v[236:239], a[244:247], v[156:159], v[236:239]
  s_waitcnt vmcnt(10)
  v_mfma_f32_16x16x32_bf16 v[160:163], a[248:251], v[64:67], v[160:163]
  v_mfma_f32_16x16x32_bf16 v[180:183], a[248:251], v[68:71], v[180:183]
  v_mfma_f32_16x16x32_bf16 v[200:203], a[248:251], v[72:75], v[200:203]
  s_add_u32 s30, s26, 8192
  buffer_load_dwordx4 v[148:151], v49, s[8:11], s30 offen sc1
  v_mfma_f32_16x16x32_bf16 v[220:223], a[248:251], v[76:79], v[220:223]
  v_mfma_f32_16x16x32_bf16 v[164:167], a[252:255], v[64:67], v[164:167]
  v_mfma_f32_16x16x32_bf16 v[184:187], a[252:255], v[68:71], v[184:187]
  v_mfma_f32_16x16x32_bf16 v[204:207], a[252:255], v[72:75], v[204:207]
  s_add_u32 s30, s26, 0
  buffer_load_dwordx4 v[120:123], v50, s[8:11], s30 offen sc1
  v_mfma_f32_16x16x32_bf16 v[224:227], a[252:255], v[76:79], v[224:227]
  v_mfma_f32_16x16x32_bf16 v[168:171], a[0:3], v[64:67], v[168:171]
  v_mfma_f32_16x16x32_bf16 v[188:191], a[0:3], v[68:71], v[188:191]
  v_mfma_f32_16x16x32_bf16 v[208:211], a[0:3], v[72:75], v[208:211]
  s_add_u32 s30, s26, 4096
  buffer_load_dwordx4 v[136:139], v50, s[8:11], s30 offen sc1
  v_mfma_f32_16x16x32_bf16 v[228:231], a[0:3], v[76:79], v[228:231]
  v_mfma_f32_16x16x32_bf16 v[172:175], a[4:7], v[64:67], v[172:175]
  v_mfma_f32_16x16x32_bf16 v[192:195], a[4:7], v[68:71], v[192:195]
  v_mfma_f32_16x16x32_bf16 v[212:215], a[4:7], v[72:75], v[212:215]
  s_add_u32 s30, s26, 8192
  buffer_load_dwordx4 v[152:155], v50, s[8:11], s30 offen sc1
  v_mfma_f32_16x16x32_bf16 v[232:235], a[4:7], v[76:79], v[232:235]
  v_mfma_f32_16x16x32_bf16 v[176:179], a[8:11], v[64:67], v[176:179]
  v_mfma_f32_16x16x32_bf16 v[196:199], a[8:11], v[68:71], v[196:199]
  v_mfma_f32_16x16x32_bf16 v[216:219], a[8:11], v[72:75], v[216:219]
  s_add_u32 s30, s26, 0
  buffer_load_dwordx4 v[124:127], v51, s[8:11], s30 offen sc1
  v_mfma_f32_16x16x32_bf16 v[236:239], a[8:11], v[76:79], v[236:239]
  s_waitcnt vmcnt(11)
  v_mfma_f32_16x16x32_bf16 v[160:163], a[12:15], v[80:83], v[160:163]
  v_mfma_f32_16x16x32_bf16 v[180:183], a[12:15], v[84:87], v[180:183]
  v_mfma_f32_16x16x32_bf16 v[200:203], a[12:15], v[88:91], v[200:203]
  s_add_u32 s30, s26, 4096
  buffer_load_dwordx4 v[140:143], v51, s[8:11], s30 offen sc1
  v_mfma_f32_16x16x32_bf16 v[220:223], a[12:15], v[92:95], v[220:223]
  v_mfma_f32_16x16x32_bf16 v[164:167], a[16:19], v[80:83], v[164:167]
  v_mfma_f32_16x16x32_bf16 v[184:187], a[16:19], v[84:87], v[184:187]
  v_mfma_f32_16x16x32_bf16 v[204:207], a[16:19], v[88:91], v[204:207]
  s_add_u32 s30, s26, 8192
  buffer_load_dwordx4 v[156:159], v51, s[8:11], s30 offen sc1
  v_mfma_f32_16x16x32_bf16 v[224:227], a[16:19], v[92:95], v[224:227]
  v_mfma_f32_16x16x32_bf16 v[168:171], a[20:23], v[80:83], v[168:171]
  v_mfma_f32_16x16x32_bf16 v[188:191], a[20:23], v[84:87], v[188:191]
  v_mfma_f32_16x16x32_bf16 v[208:211], a[20:23], v[88:91], v[208:211]
  s_add_u32 s30, s26, 0
  buffer_load_dwordx4 v[112:115], v48, s[8:11], s30 offen sc1
  v_mfma_f32_16x16x32_bf16 v[228:231], a[20:23], v[92:95], v[228:231]
  v_mfma_f32_16x16x32_bf16 v[172:175], a[24:27], v[80:83], v[172:175]
  v_mfma_f32_16x16x32_bf16 v[192:195], a[24:27], v[84:87], v[192:195]
  v_mfma_f32_16x16x32_bf16 v[212:215], a[24:27], v[88:91], v[212:215]
  s_add_u32 s30, s26, 4096
  buffer_load_dwordx4 v[128:131], v48, s[8:11], s30 offen sc1
  v_mfma_f32_16x16x32_bf16 v[232:235], a[24:27], v[92:95], v[232:235]
  v_mfma_f32_16x16x32_bf16 v[176:179], a[28:31], v[80:83], v[176:179]
  v_mfma_f32_16x16x32_bf16 v[196:199], a[28:31], v[84:87], v[196:199]
  v_mfma_f32_16x16x32_bf16 v[216:219], a[28:31], v[88:91], v[216:219]
  s_add_u32 s30, s26, 8192
  buffer_load_dwordx4 v[144:147], v48, s[8:11], s30 offen sc1
  v_mfma_f32_16x16x32_bf16 v[236:239], a[28:31], v[92:95], v[236:239]
  s_waitcnt vmcnt(12)
  v_mfma_f32_16x16x32_bf16 v[160:163], a[32:35], v[96:99], v[160:163]
  v_mfma_f32_16x16x32_bf16 v[180:183], a[32:35], v[100:103], v[180:183]
  v_mfma_f32_16x16x32_bf16 v[200:203], a[32:35], v[104:107], v[200:203]
  v_mfma_f32_16x16x32_bf16 v[220:223], a[32:35], v[108:111], v[220:223]
  v_mfma_f32_16x16x32_bf16 v[164:167], a[36:39], v[96:99], v[164:167]
  v_mfma_f32_16x16x32_bf16 v[184:187], a[36:39], v[100:103], v[184:187]
  v_mfma_f32_16x16x32_bf16 v[204:207], a[36:39], v[104:107], v[204:207]
  v_mfma_f32_16x16x32_bf16 v[224:227], a[36:39], v[108:111], v[224:227]
  v_mfma_f32_16x16x32_bf16 v[168:171], a[40:43], v[96:99], v[168:171]
  v_mfma_f32_16x16x32_bf16 v[188:191], a[40:43], v[100:103], v[188:191]
  v_mfma_f32_16x16x32_bf16 v[208:211], a[40:43], v[104:107], v[208:211]
  v_mfma_f32_16x16x32_bf16 v[228:231], a[40:43], v[108:111], v[228:231]
  v_mfma_f32_16x16x32_bf16 v[172:175], a[44:47], v[96:99], v[172:175]
  v_mfma_f32_16x16x32_bf16 v[192:195], a[44:47], v[100:103], v[192:195]
  v_mfma_f32_16x16x32_bf16 v[212:215], a[44:47], v[104:107], v[212:215]
  v_mfma_f32_16x16x32_bf16 v[232:235], a[44:47], v[108:111], v[232:235]
  v_mfma_f32_16x16x32_bf16 v[176:179], a[48:51], v[96:99], v[176:179]
  v_mfma_f32_16x16x32_bf16 v[196:199], a[48:51], v[100:103], v[196:199]
  v_mfma_f32_16x16x32_bf16 v[216:219], a[48:51], v[104:107], v[216:219]
  v_mfma_f32_16x16x32_bf16 v[236:239], a[48:51], v[108:111], v[236:239]
  s_waitcnt vmcnt(11)
  v_mfma_f32_16x16x32_bf16 v[180:183], a[52:55], v[116:119], v[180:183]
  v_mfma_f32_16x16x32_bf16 v[184:187], a[56:59], v[116:119], v[184:187]
  v_mfma_f32_16x16x32_bf16 v[188:191], a[60:63], v[116:119], v[188:191]
  v_mfma_f32_16x16x32_bf16 v[192:195], a[64:67], v[116:119], v[192:195]
  v_mfma_f32_16x16x32_bf16 v[196:199], a[68:71], v[116:119], v[196:199]
  s_waitcnt vmcnt(10)
  v_mfma_f32_16x16x32_bf16 v[180:183], a[72:75], v[132:135], v[180:183]
  v_mfma_f32_16x16x32_bf16 v[184:187], a[76:79], v[132:135], v[184:187]
  v_mfma_f32_16x16x32_bf16 v[188:191], a[80:83], v[132:135], v[188:191]
  v_mfma_f32_16x16x32_bf16 v[192:195], a[84:87], v[132:135], v[192:195]
  v_mfma_f32_16x16x32_bf16 v[196:199], a[88:91], v[132:135], v[196:199]
  s_waitcnt vmcnt(9)
  v_mfma_f32_16x16x32_bf16 v[180:183], a[92:95], v[148:151], v[180:183]
  v_mfma_f32_16x16x32_bf16 v[184:187], a[96:99], v[148:151], v[184:187]
  v_mfma_f32_16x16x32_bf16 v[188:191], a[100:103], v[148:151], v[188:191]
  v_mfma_f32_16x16x32_bf16 v[192:195], a[104:107], v[148:151], v[192:195]
  v_mfma_f32_16x16x32_bf16 v[196:199], a[108:111], v[148:151], v[196:199]
  s_waitcnt vmcnt(8)
  v_mfma_f32_16x16x32_bf16 v[200:203], a[52:55], v[120:123], v[200:203]
  v_mfma_f32_16x16x32_bf16 v[204:207], a[56:59], v[120:123], v[204:207]
  v_mfma_f32_16x16x32_bf16 v[208:211], a[60:63], v[120:123], v[208:211]
  v_mfma_f32_16x16x32_bf16 v[212:215], a[64:67], v[120:123], v[212:215]
  ds_write_b128 v52, v[180:183] offset:0
  v_mfma_f32_16x16x32_bf16 v[216:219], a[68:71], v[120:123], v[216:219]
  s_waitcnt vmcnt(7)
  v_mfma_f32_16x16x32_bf16 v[200:203], a[72:75], v[136:139], v[200:203]
  ds_write_b128 v52, v[184:187] offset:1024
  v_mfma_f32_16x16x32_bf16 v[204:207], a[76:79], v[136:139], v[204:207]
  v_mfma_f32_16x16x32_bf16 v[208:211], a[80:83], v[136:139], v[208:211]
  ds_write_b128 v52, v[188:191] offset:2048
  v_mfma_f32_16x16x32_bf16 v[212:215], a[84:87], v[136:139], v[212:215]
  v_mfma_f32_16x16x32_bf16 v[216:219], a[88:91], v[136:139], v[216:219]
  ds_write_b128 v52, v[192:195] offset:3072
  s_waitcnt vmcnt(6)
  v_mfma_f32_16x16x32_bf16 v[200:203], a[92:95], v[152:155], v[200:203]
  v_mfma_f32_16x16x32_bf16 v[204:207], a[96:99], v[152:155], v[204:207]
  ds_write_b128 v52, v[196:199] offset:4096
  v_mfma_f32_16x16x32_bf16 v[208:211], a[100:103], v[152:155], v[208:211]
  v_mfma_f32_16x16x32_bf16 v[212:215], a[104:107], v[152:155], v[212:215]
  v_mfma_f32_16x16x32_bf16 v[216:219], a[108:111], v[152:155], v[216:219]
  s_waitcnt vmcnt(5)
  v_mfma_f32_16x16x32_bf16 v[220:223], a[52:55], v[124:127], v[220:223]
  s_add_u32 s47, s40, 0
  s_add_u32 s58, s4, s47
  s_addc_u32 s59, s5, 0
  global_load_dwordx4 a[128:131], v2, s[58:59] offset:0
  v_mfma_f32_16x16x32_bf16 v[224:227], a[56:59], v[124:127], v[224:227]
  v_mfma_f32_16x16x32_bf16 v[228:231], a[60:63], v[124:127], v[228:231]
  global_load_dwordx4 a[132:135], v2, s[58:59] offset:1024
  v_mfma_f32_16x16x32_bf16 v[232:235], a[64:67], v[124:127], v[232:235]
  ds_write_b128 v53, v[200:203] offset:0
  v_mfma_f32_16x16x32_bf16 v[236:239], a[68:71], v[124:127], v[236:239]
  global_load_dwordx4 a[136:139], v2, s[58:59] offset:2048
  s_waitcnt vmcnt(7)
  v_mfma_f32_16x16x32_bf16 v[220:223], a[72:75], v[140:143], v[220:223]
  ds_write_b128 v53, v[204:207] offset:1024
  v_mfma_f32_16x16x32_bf16 v[224:227], a[76:79], v[140:143], v[224:227]
  global_load_dwordx4 a[140:143], v2, s[58:59] offset:3072
  v_mfma_f32_16x16x32_bf16 v[228:231], a[80:83], v[140:143], v[228:231]
  ds_write_b128 v53, v[208:211] offset:2048
  v_mfma_f32_16x16x32_bf16 v[232:235], a[84:87], v[140:143], v[232:235]
  s_add_u32 s58, s58, 4096
  s_addc_u32 s59, s59, 0
  global_load_dwordx4 a[144:147], v2, s[58:59] offset:0
  v_mfma_f32_16x16x32_bf16 v[236:239], a[88:91], v[140:143], v[236:239]
  ds_write_b128 v53, v[212:215] offset:3072
  s_waitcnt vmcnt(8)
  v_mfma_f32_16x16x32_bf16 v[220:223], a[92:95], v[156:159], v[220:223]
  global_load_dwordx4 a[148:151], v2, s[58:59] offset:1024
  v_mfma_f32_16x16x32_bf16 v[224:227], a[96:99], v[156:159], v[224:227]
  ds_write_b128 v53, v[216:219] offset:4096
  v_mfma_f32_16x16x32_bf16 v[228:231], a[100:103], v[156:159], v[228:231]
  global_load_dwordx4 a[152:155], v2, s[58:59] offset:2048
  v_mfma_f32_16x16x32_bf16 v[232:235], a[104:107], v[156:159], v[232:235]
  v_mfma_f32_16x16x32_bf16 v[236:239], a[108:111], v[156:159], v[236:239]
  global_load_dwordx4 a[156:159], v2, s[58:59] offset:3072
  s_waitcnt vmcnt(10)
  v_mfma_f32_16x16x32_bf16 v[160:163], a[52:55], v[112:115], v[160:163]
  s_add_u32 s58, s58, 4096
  s_addc_u32 s59, s59, 0
  global_load_dwordx4 a[160:163], v2, s[58:59] offset:0
  v_mfma_f32_16x16x32_bf16 v[164:167], a[56:59], v[112:115], v[164:167]
  v_mfma_f32_16x16x32_bf16 v[168:171], a[60:63], v[112:115], v[168:171]
  global_load_dwordx4 a[164:167], v2, s[58:59] offset:1024
  v_mfma_f32_16x16x32_bf16 v[172:175], a[64:67], v[112:115], v[172:175]
  ds_write_b128 v54, v[220:223] offset:0
  v_mfma_f32_16x16x32_bf16 v[176:179], a[68:71], v[112:115], v[176:179]
  global_load_dwordx4 a[168:171], v2, s[58:59] offset:2048
  s_waitcnt vmcnt(12)
  v_mfma_f32_16x16x32_bf16 v[160:163], a[72:75], v[128:131], v[160:163]
  ds_write_b128 v54, v[224:227] offset:1024
  v_mfma_f32_16x16x32_bf16 v[164:167], a[76:79], v[128:131], v[164:167]
  global_load_dwordx4 a[172:175], v2, s[58:59] offset:3072
  v_mfma_f32_16x16x32_bf16 v[168:171], a[80:83], v[128:131], v[168:171]
  ds_write_b128 v54, v[228:231] offset:2048
  v_mfma_f32_16x16x32_bf16 v[172:175], a[84:87], v[128:131], v[172:175]
  v_mfma_f32_16x16x32_bf16 v[176:179], a[88:91], v[128:131], v[176:179]
  ds_write_b128 v54, v[232:235] offset:3072
  s_waitcnt vmcnt(12)
  v_mfma_f32_16x16x32_bf16 v[160:163], a[92:95], v[144:147], v[160:163]
  v_mfma_f32_16x16x32_bf16 v[164:167], a[96:99], v[144:147], v[164:167]
  ds_write_b128 v54, v[236:239] offset:4096
  v_mfma_f32_16x16x32_bf16 v[168:171], a[100:103], v[144:147], v[168:171]
  v_mfma_f32_16x16x32_bf16 v[172:175], a[104:107], v[144:147], v[172:175]
  v_mfma_f32_16x16x32_bf16 v[176:179], a[108:111], v[144:147], v[176:179]
  s_waitcnt lgkmcnt(0)
  s_barrier
  ds_read_b128 v[180:183], v55 offset:0
  ds_read_b128 v[184:187], v55 offset:1024
  ds_read_b128 v[188:191], v55 offset:2048
  ds_read_b128 v[192:195], v55 offset:3072
  ds_read_b128 v[196:199], v55 offset:4096
  ds_read_b128 v[200:203], v55 offset:5120
  ds_read_b128 v[204:207], v55 offset:6144
  ds_read_b128 v[208:211], v55 offset:7168
  ds_read_b128 v[212:215], v55 offset:8192
  ds_read_b128 v[216:219], v55 offset:9216
  ds_read_b128 v[220:223], v55 offset:10240
  ds_read_b128 v[224:227], v55 offset:11264
  ds_read_b128 v[228:231], v55 offset:12288
  ds_read_b128 v[232:235], v55 offset:13312
  ds_read_b128 v[236:239], v55 offset:14336
  s_waitcnt lgkmcnt(14)
  v_pk_add_f32 v[160:161], v[160:161], v[180:181]
  v_pk_add_f32 v[162:163], v[162:163], v[182:183]
  s_waitcnt lgkmcnt(13)
  v_pk_add_f32 v[164:165], v[164:165], v[184:185]
  v_pk_add_f32 v[166:167], v[166:167], v[186:187]
  s_waitcnt lgkmcnt(12)
  v_pk_add_f32 v[168:169], v[168:169], v[188:189]
  v_pk_add_f32 v[170:171], v[170:171], v[190:191]
  s_waitcnt lgkmcnt(11)
  v_pk_add_f32 v[172:173], v[172:173], v[192:193]
  v_pk_add_f32 v[174:175], v[174:175], v[194:195]
  s_waitcnt lgkmcnt(10)
  v_pk_add_f32 v[176:177], v[176:177], v[196:197]
  v_pk_add_f32 v[178:179], v[178:179], v[198:199]
  s_waitcnt lgkmcnt(9)
  v_pk_add_f32 v[160:161], v[160:161], v[200:201]
  v_pk_add_f32 v[162:163], v[162:163], v[202:203]
  s_waitcnt lgkmcnt(8)
  v_pk_add_f32 v[164:165], v[164:165], v[204:205]
  v_pk_add_f32 v[166:167], v[166:167], v[206:207]
  s_waitcnt lgkmcnt(7)
  v_pk_add_f32 v[168:169], v[168:169], v[208:209]
  v_pk_add_f32 v[170:171], v[170:171], v[210:211]
  s_waitcnt lgkmcnt(6)
  v_pk_add_f32 v[172:173], v[172:173], v[212:213]
  v_pk_add_f32 v[174:175], v[174:175], v[214:215]
  s_waitcnt lgkmcnt(5)
  v_pk_add_f32 v[176:177], v[176:177], v[216:217]
  v_pk_add_f32 v[178:179], v[178:179], v[218:219]
  s_waitcnt lgkmcnt(4)
  v_pk_add_f32 v[160:161], v[160:161], v[220:221]
  v_pk_add_f32 v[162:163], v[162:163], v[222:223]
  s_waitcnt lgkmcnt(3)
  v_pk_add_f32 v[164:165], v[164:165], v[224:225]
  v_pk_add_f32 v[166:167], v[166:167], v[226:227]
  s_waitcnt lgkmcnt(2)
  v_pk_add_f32 v[168:169], v[168:169], v[228:229]
  v_pk_add_f32 v[170:171], v[170:171], v[230:231]
  s_waitcnt lgkmcnt(1)
  v_pk_add_f32 v[172:173], v[172:173], v[232:233]
  v_pk_add_f32 v[174:175], v[174:175], v[234:235]
  s_waitcnt lgkmcnt(0)
  v_pk_add_f32 v[176:177], v[176:177], v[236:237]
  v_pk_add_f32 v[178:179], v[178:179], v[238:239]
  s_cmp_eq_u32 s19, 1
  s_cbranch_scc1 FFN2_FINAL
  v_cvt_pk_bf16_f32 v240, v160, v161
  v_cvt_pk_bf16_f32 v241, v162, v163
  buffer_store_dwordx2 v[240:241], v5, s[8:11], s28 offen offset:0 sc1
  v_cvt_pk_bf16_f32 v242, v164, v165
  v_cvt_pk_bf16_f32 v243, v166, v167
  buffer_store_dwordx2 v[242:243], v5, s[8:11], s28 offen offset:2048 sc1
  v_cvt_pk_bf16_f32 v244, v168, v169
  v_cvt_pk_bf16_f32 v245, v170, v171
  s_add_u32 s28, s28, 4096
  buffer_store_dwordx2 v[244:245], v5, s[8:11], s28 offen offset:0 sc1
  v_cvt_pk_bf16_f32 v246, v172, v173
  v_cvt_pk_bf16_f32 v247, v174, v175
  buffer_store_dwordx2 v[246:247], v5, s[8:11], s28 offen offset:2048 sc1
  v_cvt_pk_bf16_f32 v248, v176, v177
  v_cvt_pk_bf16_f32 v249, v178, v179
  s_add_u32 s28, s28, 4096
  buffer_store_dwordx2 v[248:249], v5, s[8:11], s28 offen offset:0 sc1
  v_pk_mul_f32 v[24:25], v[160:161], v[160:161]
  v_pk_add_f32 v[22:23], v[160:161], v[162:163]
  v_pk_fma_f32 v[24:25], v[162:163], v[162:163], v[24:25]
  v_pk_add_f32 v[22:23], v[22:23], v[164:165]
  v_pk_fma_f32 v[24:25], v[164:165], v[164:165], v[24:25]
  v_pk_add_f32 v[22:23], v[22:23], v[166:167]
  v_pk_fma_f32 v[24:25], v[166:167], v[166:167], v[24:25]
  v_pk_add_f32 v[22:23], v[22:23], v[168:169]
  v_pk_fma_f32 v[24:25], v[168:169], v[168:169], v[24:25]
  v_pk_add_f32 v[22:23], v[22:23], v[170:171]
  v_pk_fma_f32 v[24:25], v[170:171], v[170:171], v[24:25]
  v_pk_add_f32 v[22:23], v[22:23], v[172:173]
  v_pk_fma_f32 v[24:25], v[172:173], v[172:173], v[24:25]
  v_pk_add_f32 v[22:23], v[22:23], v[174:175]
  v_pk_fma_f32 v[24:25], v[174:175], v[174:175], v[24:25]
  v_pk_add_f32 v[22:23], v[22:23], v[176:177]
  v_pk_fma_f32 v[24:25], v[176:177], v[176:177], v[24:25]
  v_pk_add_f32 v[22:23], v[22:23], v[178:179]
  v_pk_fma_f32 v[24:25], v[178:179], v[178:179], v[24:25]
  v_add_f32 v22, v22, v23
  v_add_f32 v23, v24, v25
  v_mov_b32 v6, v22
  v_mov_b32 v7, v23
  s_nop 0
  v_permlane16_swap_b32 v22, v6
  v_permlane16_swap_b32 v23, v7
  v_add_f32 v22, v22, v6
  v_add_f32 v23, v23, v7
  v_mov_b32 v6, v22
  v_mov_b32 v7, v23
  s_nop 0
  v_permlane32_swap_b32 v22, v6
  v_permlane32_swap_b32 v23, v7
  v_add_f32 v22, v22, v6
  v_add_f32 v23, v23, v7
  buffer_store_dwordx2 v[22:23], v28, s[8:11], s29 offen sc1
  s_waitcnt vmcnt(0)
  s_barrier
  s_cmp_lg_u32 s18, 0
  s_cbranch_scc1 ARR_s4
  v_mov_b32 v6, 0
  v_mov_b32 v7, 1
  s_mov_b64 exec, 1
  buffer_atomic_add v7, v6, s[8:11], s53 offen sc1
  s_mov_b64 exec, -1
ARR_s4:
  s_nop 0
  s_add_u32 s52, s52, 8
  s_add_u32 s47, s40, 12288
  s_add_u32 s58, s4, s47
  s_addc_u32 s59, s5, 0
  global_load_dwordx4 a[176:179], v2, s[58:59] offset:0
  global_load_dwordx4 a[180:183], v2, s[58:59] offset:1024
  global_load_dwordx4 a[184:187], v2, s[58:59] offset:2048
  global_load_dwordx4 a[188:191], v2, s[58:59] offset:3072
  s_add_u32 s58, s58, 4096
  s_addc_u32 s59, s59, 0
  global_load_dwordx4 a[192:195], v2, s[58:59] offset:0
  v_mov_b32 v253, 0
  s_cmp_lg_u32 s18, 0
  s_cbranch_scc1 PL0_s4
  buffer_load_dword v254, v253, s[8:11], s53 offen sc1
PL0_s4:
  global_load_dwordx4 a[196:199], v2, s[58:59] offset:1024
  global_load_dwordx4 a[200:203], v2, s[58:59] offset:2048
  global_load_dwordx4 a[204:207], v2, s[58:59] offset:3072
  s_cmp_lg_u32 s18, 0
  s_cbranch_scc1 POLLE_s4
  s_waitcnt vmcnt(3)
  s_mov_b32 s23, 0
  v_cmp_le_u32 vcc, s52, v254
  s_nop 3
  s_cmp_eq_u64 vcc, exec
  s_cbranch_scc1 POLLD_s4
POLL_s4:
  buffer_load_dword v254, v253, s[8:11], s53 offen sc1
  s_waitcnt vmcnt(0)
  s_add_u32 s23, s23, 1
  v_cmp_le_u32 vcc, s52, v254
  s_nop 3
  s_cmp_eq_u64 vcc, exec
  s_cbranch_scc1 POLLD_s4
  s_cmp_lt_u32 s23, 400000
  s_cbranch_scc1 POLL_s4
POLLD_s4:
POLLE_s4:
  s_barrier
  s_mov_b32 s19, 1
  s_mov_b32 s20, 0x1cf0000
  s_add_u32 s43, s43, 0x1cf0000
  s_branch LAYER
FFN2_FINAL:
  s_lshl_b32 s21, s16, 6
  s_lshl_b32 s22, s31, 4
  s_add_u32 s21, s21, s22
  s_mul_i32 s28, s21, 1280
  s_mul_i32 s21, s17, 160
  s_add_u32 s28, s28, s21
  s_mul_i32 s21, s18, 2816
  v_and_b32 v6, 15, v1
  v_mul_u32_u24 v30, 176, v6
  v_lshrrev_b32 v7, 4, v1
  v_lshl_add_u32 v30, v7, 3, v30
  v_add_u32 v30, s21, v30
  v_add_u32 v30, 65536, v30
  v_cvt_pk_bf16_f32 v240, v160, v161
  v_cvt_pk_bf16_f32 v241, v162, v163
  ds_write_b64 v30, v[240:241] offset:0
  v_cvt_pk_bf16_f32 v242, v164, v165
  v_cvt_pk_bf16_f32 v243, v166, v167
  ds_write_b64 v30, v[242:243] offset:32
  v_cvt_pk_bf16_f32 v244, v168, v169
  v_cvt_pk_bf16_f32 v245, v170, v171
  ds_write_b64 v30, v[244:245] offset:64
  v_cvt_pk_bf16_f32 v246, v172, v173
  v_cvt_pk_bf16_f32 v247, v174, v175
  ds_write_b64 v30, v[246:247] offset:96
  v_cvt_pk_bf16_f32 v248, v176, v177
  v_cvt_pk_bf16_f32 v249, v178, v179
  ds_write_b64 v30, v[248:249] offset:128
  v_mul_u32_u24 v6, 6554, v1
  v_lshrrev_b32 v6, 16, v6
  v_mul_u32_u24 v7, 10, v6
  v_sub_u32 v7, v1, v7
  v_mul_u32_u24 v31, 176, v6
  v_lshl_add_u32 v31, v7, 4, v31
  v_add_u32 v31, s21, v31
  v_add_u32 v31, 65536, v31
  v_mul_u32_u24 v32, 1280, v6
  v_lshl_add_u32 v32, v7, 4, v32
  s_waitcnt lgkmcnt(0)
  ds_read_b128 v[64:67], v31 offset:0
  ds_read_b128 v[68:71], v31 offset:1056
  ds_read_b128 v[72:75], v31 offset:2112
  v_cmp_gt_u32 vcc, 60, v1
  v_mov_b32 v8, 0x40000000
  s_nop 0
  v_cndmask_b32 v9, v8, v32, vcc
  s_waitcnt lgkmcnt(2)
  buffer_store_dwordx4 v[64:67], v9, s[12:15], s28 offen
  s_add_u32 s28, s28, 7680
  v_cmp_gt_u32 vcc, 60, v1
  v_mov_b32 v8, 0x40000000
  s_nop 0
  v_cndmask_b32 v9, v8, v32, vcc
  s_waitcnt lgkmcnt(1)
  buffer_store_dwordx4 v[68:71], v9, s[12:15], s28 offen
  s_add_u32 s28, s28, 7680
  v_cmp_gt_u32 vcc, 40, v1
  v_mov_b32 v8, 0x40000000
  s_nop 0
  v_cndmask_b32 v9, v8, v32, vcc
  s_waitcnt lgkmcnt(0)
  buffer_store_dwordx4 v[72:75], v9, s[12:15], s28 offen
MAIN_END:
  s_endpgm
.section .rodata,"a"
.p2align 6
.amdhsa_kernel l0_kernel
  .amdhsa_next_free_vgpr 128
  .amdhsa_next_free_sgpr 102
  .amdhsa_accum_offset 128
  .amdhsa_group_segment_fixed_size 0
  .amdhsa_kernarg_size 104
  .amdhsa_user_sgpr_count 2
  .amdhsa_user_sgpr_kernarg_segment_ptr 1
  .amdhsa_system_sgpr_workgroup_id_x 1
  .amdhsa_float_denorm_mode_32 3
.end_amdhsa_kernel
.p2align 6
.amdhsa_kernel main_kernel
  .amdhsa_next_free_vgpr 512
  .amdhsa_next_free_sgpr 102
  .amdhsa_accum_offset 256
  .amdhsa_group_segment_fixed_size 0
  .amdhsa_kernarg_size 104
  .amdhsa_user_sgpr_count 2
  .amdhsa_user_sgpr_kernarg_segment_ptr 1
  .amdhsa_system_sgpr_workgroup_id_x 1
  .amdhsa_float_denorm_mode_32 3
.end_amdhsa_kernel
```
